```python
import torch

def _softmax(x, axis=-1):
    return torch.softmax(x, dim=axis)
def _gelu(x):
    return torch.nn.functional.gelu(x, approximate="tanh")
def _silu(x):
    return torch.nn.functional.silu(x)
def _sigmoid(x):
    return torch.sigmoid(x)
def _layernorm(x, axis=-1, eps=1e-5):
    m = x.mean(dim=axis, keepdim=True)
    v = x.var(dim=axis, keepdim=True, unbiased=False)
    return (x - m) / torch.sqrt(v + eps)
def _scatter_add(tgt, idx, src, axis=0):
    return tgt.clone().index_add_(axis, idx, src)
def _segment_sum(src, seg, n):
    out = torch.zeros((n,) + src.shape[1:], dtype=src.dtype)
    return out.index_add_(0, seg, src)
def _pad(x, pw):
    flat = tuple(v for pair in reversed(pw) for v in pair)
    return torch.nn.functional.pad(x, flat)

kernel_name = 'recurrent_scan__linear_attn_block__glu_gated_geglu__prompt'

def setup_inputs():

    _w = (lambda a: (lambda t: t.to(torch.bfloat16) if t.is_floating_point() else t)(torch.as_tensor(a)))
    def _A_setup():
        B, S, D = 1, 2048, 512
        return {
            "x": _w((lambda *s: torch.randn(*s, dtype=torch.bfloat16) * 0.05)(B, S, D)),
            "wqkv": _w((lambda *s: torch.randn(*s, dtype=torch.bfloat16) * 0.8)(D, 3 * D)),
            "wo": _w((lambda *s: torch.randn(*s, dtype=torch.bfloat16) * 0.8)(D, D)),
        }
    _A_in = _A_setup()

    def _B_setup():
        B, S, Dm, Df = 1, 2048, 512, 1376
        return {
            "x": _w((lambda *s: torch.randn(*s, dtype=torch.bfloat16) * 0.05)(B, S, Dm)),
            "w_gate": _w((lambda *s: torch.randn(*s, dtype=torch.bfloat16) * 0.2)(Dm, Df) * (Dm ** -0.5)),
            "w_up": _w((lambda *s: torch.randn(*s, dtype=torch.bfloat16) * 0.2)(Dm, Df) * (Dm ** -0.5)),
            "w_down": _w((lambda *s: torch.randn(*s, dtype=torch.bfloat16) * 0.2)(Df, Dm) * (Df ** -0.5)),
        }
    _B_in = _B_setup()

    return {
        "A_x": _A_in["x"],
        "A_wqkv": _A_in["wqkv"],
        "A_wo": _A_in["wo"],
        "B_x": _B_in["x"],
        "B_w_gate": _B_in["w_gate"],
        "B_w_up": _B_in["w_up"],
        "B_w_down": _B_in["w_down"],
    }

def reference(A_x, A_wqkv, A_wo, B_x, B_w_gate, B_w_up, B_w_down):
    def _A_ref(x, wqkv, wo):
        B, S, D = x.shape
        H = 32; Dh = D // H
        qkv = (lambda x, *d: x.permute(*d))((x @ wqkv).reshape(B, S, 3, H, Dh), 2, 0, 3, 1, 4)
        q, k, v = qkv[0], qkv[1], qkv[2]
        phi = lambda t: torch.where(t > 0, t + 1, torch.exp(t)) + 1e-6
        pq, pk = phi(q), phi(k)
        kv = torch.einsum("bhsd,bhse->bhde", pk, v)
        z = torch.einsum("bhsd->bhd", pk)
        num = torch.einsum("bhqd,bhde->bhqe", pq, kv)
        den = torch.einsum("bhqd,bhd->bhq", pq, z)[..., None] + 1e-6
        o = num / den
        return (lambda x, *d: x.permute(*d))(o, 0, 2, 1, 3).reshape(B, S, D) @ wo

    def _B_ref(x, w_gate, w_up, w_down):
        g = torch.einsum("bsd,df->bsf", x, w_gate)
        u = torch.einsum("bsd,df->bsf", x, w_up)
        h = _gelu(g) * u
        return torch.einsum("bsf,fd->bsd", h, w_down)

    x = A_x
    xn = _layernorm(x, axis=-1)
    s = _A_ref(xn, A_wqkv, A_wo)
    g = _silu(_B_ref(xn, B_w_gate, B_w_up, B_w_down))
    return x + s * g
```

```asm
; @launch grid=(256,1,1) block=(512,1,1) lds=163840
.amdgcn_target "amdgcn-amd-amdhsa--gfx950"
.text
.globl recurrent_scan__linear_attn_block__glu_gated_geglu__prompt_kernel
.p2align 8
.type recurrent_scan__linear_attn_block__glu_gated_geglu__prompt_kernel,@function
recurrent_scan__linear_attn_block__glu_gated_geglu__prompt_kernel:
    s_load_dwordx2 s[4:5], s[0:1], 0
    s_load_dwordx4 s[28:31], s[0:1], 8
    s_load_dwordx8 s[80:87], s[0:1], 32
    s_load_dwordx4 s[36:39], s[0:1], 64
    s_cmp_ge_u32 s2, 256
    s_cbranch_scc1 K_END
    s_and_b32 s3, s2, 3
    s_bfe_u32 s64, s2, 0x20003
    s_lshl_b32 s3, s3, 2
    s_add_u32 s43, s3, s64
    s_lshr_b32 s65, s2, 5
    v_bfe_u32 v3, v0, 3, 5
    v_and_b32 v4, 7, v0
    s_and_b32 s60, s65, 3
    s_and_b32 s63, s65, 0
    v_bfe_u32 v5, v0, 4, 3
    v_xor_b32 v5, v5, v4
    v_lshlrev_b32 v19, 10, v3
    v_lshl_add_u32 v19, v5, 4, v19
    s_lshl2_add_u32 s70, s43, s60
    s_lshl_b32 s70, s70, 8
    s_or_b32 s70, s70, s63
    s_lshl_b32 s70, s70, 7
    s_mov_b32 s6, 0x200000
    s_mov_b32 s7, 0x00020000
    v_cmp_gt_u32 vcc, 0x100, v0
    s_cbranch_vccnz K1_cpf
    s_waitcnt lgkmcnt(0)
    buffer_load_dwordx4 v[96:99], v19, s[4:7], s70 offen offset:0
    buffer_load_dwordx4 v[112:115], v19, s[4:7], s70 offen offset:128
    buffer_load_dwordx4 v[128:131], v19, s[4:7], s70 offen offset:256
    buffer_load_dwordx4 v[144:147], v19, s[4:7], s70 offen offset:384
    s_xor_b32 s71, s70, 512
    buffer_load_dwordx4 v[160:163], v19, s[4:7], s71 offen offset:0
    buffer_load_dwordx4 v[176:179], v19, s[4:7], s71 offen offset:128
    buffer_load_dwordx4 v[192:195], v19, s[4:7], s71 offen offset:256
    buffer_load_dwordx4 v[208:211], v19, s[4:7], s71 offen offset:384
    s_branch K1_setup
K1_cpf:
    s_getpc_b64 s[66:67]
K1_pc:
    s_and_b32 s3, s2, 0xf8
    v_add_lshl_u32 v5, v0, s3, 7
    v_min_u32 v5, K_END-K1_pc, v5
    v_cmp_gt_u32 vcc, 8, v0
    s_and_saveexec_b64 s[68:69], vcc
    s_cbranch_execz K1_nocpf
    global_load_dword v21, v5, s[66:67]
K1_nocpf:
    s_mov_b64 exec, -1
K1_setup:
    v_lshrrev_b32 v2, 6, v0
    v_and_b32 v1, 63, v0
    v_readfirstlane_b32 s40, v2
    s_bfe_u32 s3, s2, 0x10002
    s_lshl_b32 s3, s3, 3
    s_add_u32 s3, s3, s65
    s_lshl_b32 s72, s2, 1
    s_and_b32 s72, s72, 7
    s_lshl_b32 s3, s3, 2
    s_mov_b32 s64, 0xeb16a054
    s_mov_b32 s65, 0xfd39c287
    s_lshr_b64 s[64:65], s[64:65], s3
    s_and_b32 s44, s64, 15
    s_and_b32 s52, s40, 3
    s_and_b32 s41, s40, 1
    s_lshr_b32 s42, s52, 1
    s_lshl_b32 s46, s44, 3
    s_mul_i32 s3, s44, 9
    s_sub_u32 s3, s3, 4
    s_cmp_ge_u32 s44, 4
    s_cselect_b32 s46, s3, s46
    s_cselect_b32 s58, 1, 0
    s_lshl_b32 s64, s46, 5
    s_lshl2_add_u32 s3, s41, s44
    s_sub_u32 s3, s3, 6
    s_lshl_b32 s3, s3, 8
    s_cmp_ge_u32 s44, 10
    s_cselect_b32 s64, s3, s64
    s_cselect_b32 s58, 2, s58
    s_movk_i32 s3, 2752
    s_cselect_b32 s45, 3072, s3
    s_lshl1_add_u32 s3, s44, s41
    s_sub_u32 s3, s3, 28
    s_lshl_b32 s3, s3, 8
    s_lshl_b32 s67, s44, 4
    s_sub_u32 s67, s67, 138
    s_cmp_ge_u32 s44, 14
    s_cselect_b32 s64, s3, s64
    s_cselect_b32 s58, 3, s58
    s_cselect_b32 s46, s67, s46
    s_lshl_b32 s59, s45, 6
    s_cmp_eq_u32 s58, 1
    s_cselect_b32 s66, 17, 15
    s_movk_i32 s67, 3641
    s_movk_i32 s68, 0x13a
    v_mul_u32_u24 v5, s67, v1
    v_lshrrev_b32 v5, 16, v5
    v_mul_u32_u24 v7, 18, v5
    v_sub_u32 v7, v1, v7
    v_min_u32 v7, s66, v7
    v_mul_u32_u24 v5, s45, v5
    v_lshl_add_u32 v10, v7, 4, v5
    v_add_u32 v6, 64, v1
    v_mul_u32_u24 v5, s67, v6
    v_lshrrev_b32 v5, 16, v5
    v_mul_u32_u24 v7, 18, v5
    v_sub_u32 v7, v6, v7
    v_min_u32 v7, s66, v7
    v_mul_u32_u24 v5, s45, v5
    v_lshl_add_u32 v11, v7, 4, v5
    v_add_u32 v6, 64, v6
    v_mul_u32_u24 v5, s67, v6
    v_lshrrev_b32 v5, 16, v5
    v_mul_u32_u24 v7, 18, v5
    v_sub_u32 v7, v6, v7
    v_min_u32 v7, s66, v7
    v_mul_u32_u24 v5, s45, v5
    v_lshl_add_u32 v12, v7, 4, v5
    v_add_u32 v6, 64, v6
    v_mul_u32_u24 v5, s67, v6
    v_lshrrev_b32 v5, 16, v5
    v_mul_u32_u24 v7, 18, v5
    v_sub_u32 v7, v6, v7
    v_min_u32 v7, s66, v7
    v_mul_u32_u24 v5, s45, v5
    v_lshl_add_u32 v13, v7, 4, v5
    v_add_u32 v6, 64, v6
    v_mul_u32_u24 v5, s67, v6
    v_lshrrev_b32 v5, 16, v5
    v_mul_u32_u24 v7, 18, v5
    v_sub_u32 v7, v6, v7
    v_min_u32 v7, s66, v7
    v_mul_u32_u24 v5, s45, v5
    v_lshl_add_u32 v14, v7, 4, v5
    v_add_u32 v6, 64, v6
    v_mul_u32_u24 v5, s67, v6
    v_lshrrev_b32 v5, 16, v5
    v_mul_u32_u24 v7, 18, v5
    v_sub_u32 v7, v6, v7
    v_min_u32 v7, s66, v7
    v_mul_u32_u24 v5, s45, v5
    v_lshl_add_u32 v15, v7, 4, v5
    v_add_u32 v6, 64, v6
    v_mul_u32_u24 v5, s67, v6
    v_lshrrev_b32 v5, 16, v5
    v_mul_u32_u24 v7, 18, v5
    v_sub_u32 v7, v6, v7
    v_min_u32 v7, s66, v7
    v_mul_u32_u24 v5, s45, v5
    v_lshl_add_u32 v16, v7, 4, v5
    v_add_u32 v6, 64, v6
    v_mul_u32_u24 v5, s67, v6
    v_lshrrev_b32 v5, 16, v5
    v_mul_u32_u24 v7, 18, v5
    v_sub_u32 v7, v6, v7
    v_min_u32 v7, s66, v7
    v_mul_u32_u24 v5, s45, v5
    v_lshl_add_u32 v17, v7, 4, v5
    v_add_u32 v6, 64, v6
    v_mul_u32_u24 v5, s67, v6
    v_lshrrev_b32 v5, 16, v5
    v_mul_u32_u24 v7, 18, v5
    v_sub_u32 v7, v6, v7
    v_min_u32 v7, s66, v7
    v_mul_u32_u24 v5, s45, v5
    v_lshl_add_u32 v18, v7, 4, v5
    s_waitcnt lgkmcnt(0)
    s_cmp_eq_u32 s41, 1
    s_cselect_b64 s[8:9], s[82:83], s[80:81]
    s_cselect_b32 s48, 18560, 0
    s_cmp_ge_u32 s58, 2
    s_cselect_b64 s[8:9], s[28:29], s[8:9]
    s_lshl_b32 s73, s59, 3
    s_add_u32 s8, s8, s64
    s_addc_u32 s9, s9, 0
    s_sub_u32 s10, s73, s64
    s_mov_b32 s11, 0x00020000
    s_mul_i32 s51, s42, s59
    s_lshr_b32 s51, s51, 1
    s_mul_i32 s3, s42, 9216
    s_add_u32 s48, s48, s3
    s_add_u32 s48, s48, 32768
    s_mov_b32 s62, 36992
    s_mov_b32 s47, 0
    s_mul_i32 s49, s72, s59
    s_mov_b32 s57, 0
    s_bfe_u32 s3, s2, 0x20003
    s_cmp_eq_u32 s3, s40
    s_cselect_b32 s78, 1, 0
    s_cbranch_scc0 K1_notlead
K1_w0:
    s_add_u32 m0, s48, 0
    s_add_u32 s50, s49, s51
    buffer_load_dwordx4 v10, s[8:11], s50 offen  lds
    s_add_u32 m0, s48, 1024
    s_nop 0
    buffer_load_dwordx4 v11, s[8:11], s50 offen  lds
    s_add_u32 m0, s48, 2048
    s_nop 0
    buffer_load_dwordx4 v12, s[8:11], s50 offen  lds
    s_add_u32 m0, s48, 3072
    s_nop 0
    buffer_load_dwordx4 v13, s[8:11], s50 offen  lds
    s_add_u32 m0, s48, 4096
    s_nop 0
    buffer_load_dwordx4 v14, s[8:11], s50 offen  lds
    s_add_u32 m0, s48, 5120
    s_add_u32 s50, s49, s51
    buffer_load_dwordx4 v15, s[8:11], s50 offen  lds
    s_add_u32 m0, s48, 6144
    s_nop 0
    buffer_load_dwordx4 v16, s[8:11], s50 offen  lds
    s_add_u32 m0, s48, 7168
    s_nop 0
    buffer_load_dwordx4 v17, s[8:11], s50 offen  lds
    s_add_u32 m0, s48, 8192
    s_nop 0
    buffer_load_dwordx4 v18, s[8:11], s50 offen  lds
    s_add_u32 s49, s49, s59
    s_add_u32 s57, s57, 1
    s_cmp_eq_u32 s49, s73
    s_cselect_b32 s49, 0, s49
    s_cmp_eq_u32 s57, 3
    s_cselect_b32 s61, 4294893312, s62
    s_cselect_b32 s57, 0, s57
    s_add_u32 s48, s48, s61
    s_cmp_eq_u32 s78, 0
    s_cbranch_scc1 K1_w0done
K1_notlead:
    s_mov_b32 s54, 0xffff0000
    s_mov_b32 s55, 0x3f803f80
    s_mov_b32 s20, s38
    s_mov_b32 s21, s39
    s_mov_b32 s22, 8486912
    s_mov_b32 s23, 0x00020000
    s_mov_b32 s24, s36
    s_mov_b32 s25, s37
    s_mov_b32 s26, 256
    s_mov_b32 s27, 0x00020000
    s_mov_b64 s[92:93], s[4:5]
    s_bfe_u32 s3, s2, 0x20001
    s_bfe_u32 s66, s2, 0x30003
    s_lshl3_add_u32 s74, s3, s66
    s_and_b32 s3, s2, 1
    s_lshr_b32 s75, s2, 6
    s_lshl2_add_u32 s75, s3, s75
    s_mul_i32 s3, s66, 5
    s_and_b32 s66, s75, 0
    s_mul_i32 s76, s66, 8
    s_mul_i32 s91, s66, 44
    s_add_u32 s91, s91, s3
    s_cmp_lt_u32 s40, 4
    s_cbranch_scc1 K1_CONS
    s_setprio 3
    s_add_u32 s3, s72, 1
    s_and_b32 s3, s3, 7
    s_mul_i32 s49, s3, s59
    s_mov_b32 s57, 1
    s_add_u32 s48, s48, 36992
    s_lshl2_add_u32 s79, s60, s52
    s_lshl_b32 s79, s79, 10
    v_lshl_add_u32 v88, v1, 4, s79
    v_xor_b32 v89, 4096, v88
    v_xor_b32 v90, 8192, v88
    v_xor_b32 v91, 12288, v88
    s_sub_u32 s53, s72, s63
    s_and_b32 s53, s53, 7
    s_lshl_b32 s53, s53, 4
    v_lshrrev_b32 v5, 3, v1
    v_bfe_u32 v6, v1, 4, 1
    v_lshlrev_b32 v6, 2, v6
    v_xor_b32 v6, v6, v4
    v_lshlrev_b32 v5, 10, v5
    v_lshl_add_u32 v21, v6, 4, v5
    v_mov_b64 v[30:31], 0
    v_mov_b64 v[32:33], 0
    v_mov_b64 v[34:35], 0
    v_mov_b64 v[36:37], 0
    s_mov_b32 s32, 0x3b000000
    s_mov_b32 s33, 0x3727c5ac
    s_lshl_b32 s3, s75, 7
    s_add_u32 s12, s30, s3
    s_addc_u32 s13, s31, 0
    s_sub_u32 s14, 524288, s3
    s_mov_b32 s15, 0x00020000
    s_add_u32 s16, s84, s3
    s_addc_u32 s17, s85, 0
    s_sub_u32 s18, 1409024, s3
    s_mov_b32 s19, 0x00020000
    s_lshl_b32 s64, s52, 10
    s_and_b32 s76, s75, 0
    s_lshl1_add_u32 s65, s52, s76
    s_lshl_b32 s65, s65, 16
    s_add_u32 s68, s91, s42
    s_lshl_b32 s68, s68, 14
    s_lshl_b32 s3, s41, 13
    s_add_u32 s68, s68, s3
    s_lshr_b32 s88, s2, 3
    s_lshl2_add_u32 s88, s88, s52
    s_lshl_b32 s3, s2, 4
    s_add_u32 s88, s88, s3
    s_and_b32 s88, s88, 127
    s_lshl_b32 s88, s88, 12
    v_lshrrev_b32 v20, 2, v1
    v_lshlrev_b32 v20, 10, v20
    v_and_b32 v5, 3, v1
    v_lshl_add_u32 v20, v5, 7, v20
    s_lshr_b32 s3, s75, 2
    s_lshl_b32 s3, s3, 9
    v_add_u32 v20, s3, v20
    v_lshrrev_b32 v3, 5, v1
    v_bfe_u32 v4, v1, 2, 2
    v_lshl_add_u32 v3, v3, 2, v4
    v_lshlrev_b32 v3, 7, v3
    v_bfe_u32 v4, v1, 3, 1
    v_lshl_add_u32 v3, v4, 6, v3
    v_bfe_u32 v4, v1, 4, 1
    v_lshl_add_u32 v3, v4, 5, v3
    v_and_b32 v4, 3, v1
    v_lshl_add_u32 v92, v4, 3, v3
    v_add_u32 v92, s64, v92
    s_lshl_b32 s3, s42, 6
    v_xor_b32 v92, s3, v92
    v_xor_b32 v93, 64, v92
    s_waitcnt vmcnt(7)
    s_xor_b32 s71, s70, 32768
    buffer_load_dwordx4 v[100:103], v19, s[4:7], s71 offen offset:0
    v_dot2c_f32_bf16 v30, s55, v96
    v_dot2c_f32_bf16 v31, v96, v96
    v_dot2c_f32_bf16 v30, s55, v97
    v_dot2c_f32_bf16 v31, v97, v97
    v_dot2c_f32_bf16 v30, s55, v98
    v_dot2c_f32_bf16 v31, v98, v98
    v_dot2c_f32_bf16 v30, s55, v99
    v_dot2c_f32_bf16 v31, v99, v99
    s_waitcnt vmcnt(7)
    buffer_load_dwordx4 v[116:119], v19, s[4:7], s71 offen offset:128
    v_dot2c_f32_bf16 v30, s55, v112
    v_dot2c_f32_bf16 v31, v112, v112
    v_dot2c_f32_bf16 v30, s55, v113
    v_dot2c_f32_bf16 v31, v113, v113
    v_dot2c_f32_bf16 v30, s55, v114
    v_dot2c_f32_bf16 v31, v114, v114
    v_dot2c_f32_bf16 v30, s55, v115
    v_dot2c_f32_bf16 v31, v115, v115
    s_waitcnt vmcnt(7)
    buffer_load_dwordx4 v[132:135], v19, s[4:7], s71 offen offset:256
    v_dot2c_f32_bf16 v30, s55, v128
    v_dot2c_f32_bf16 v31, v128, v128
    v_dot2c_f32_bf16 v30, s55, v129
    v_dot2c_f32_bf16 v31, v129, v129
    v_dot2c_f32_bf16 v30, s55, v130
    v_dot2c_f32_bf16 v31, v130, v130
    v_dot2c_f32_bf16 v30, s55, v131
    v_dot2c_f32_bf16 v31, v131, v131
    s_waitcnt vmcnt(7)
    buffer_load_dwordx4 v[148:151], v19, s[4:7], s71 offen offset:384
    v_dot2c_f32_bf16 v30, s55, v144
    v_dot2c_f32_bf16 v31, v144, v144
    v_dot2c_f32_bf16 v30, s55, v145
    v_dot2c_f32_bf16 v31, v145, v145
    v_dot2c_f32_bf16 v30, s55, v146
    v_dot2c_f32_bf16 v31, v146, v146
    v_dot2c_f32_bf16 v30, s55, v147
    v_dot2c_f32_bf16 v31, v147, v147
    s_waitcnt vmcnt(7)
    s_xor_b32 s71, s70, 33280
    buffer_load_dwordx4 v[164:167], v19, s[4:7], s71 offen offset:0
    v_dot2c_f32_bf16 v30, s55, v160
    v_dot2c_f32_bf16 v31, v160, v160
    v_dot2c_f32_bf16 v30, s55, v161
    v_dot2c_f32_bf16 v31, v161, v161
    v_dot2c_f32_bf16 v30, s55, v162
    v_dot2c_f32_bf16 v31, v162, v162
    v_dot2c_f32_bf16 v30, s55, v163
    v_dot2c_f32_bf16 v31, v163, v163
    s_waitcnt vmcnt(7)
    buffer_load_dwordx4 v[180:183], v19, s[4:7], s71 offen offset:128
    v_dot2c_f32_bf16 v30, s55, v176
    v_dot2c_f32_bf16 v31, v176, v176
    v_dot2c_f32_bf16 v30, s55, v177
    v_dot2c_f32_bf16 v31, v177, v177
    v_dot2c_f32_bf16 v30, s55, v178
    v_dot2c_f32_bf16 v31, v178, v178
    v_dot2c_f32_bf16 v30, s55, v179
    v_dot2c_f32_bf16 v31, v179, v179
    s_waitcnt vmcnt(7)
    buffer_load_dwordx4 v[196:199], v19, s[4:7], s71 offen offset:256
    v_dot2c_f32_bf16 v30, s55, v192
    v_dot2c_f32_bf16 v31, v192, v192
    v_dot2c_f32_bf16 v30, s55, v193
    v_dot2c_f32_bf16 v31, v193, v193
    v_dot2c_f32_bf16 v30, s55, v194
    v_dot2c_f32_bf16 v31, v194, v194
    v_dot2c_f32_bf16 v30, s55, v195
    v_dot2c_f32_bf16 v31, v195, v195
    s_waitcnt vmcnt(7)
    buffer_load_dwordx4 v[212:215], v19, s[4:7], s71 offen offset:384
    v_dot2c_f32_bf16 v30, s55, v208
    v_dot2c_f32_bf16 v31, v208, v208
    v_dot2c_f32_bf16 v30, s55, v209
    v_dot2c_f32_bf16 v31, v209, v209
    v_dot2c_f32_bf16 v30, s55, v210
    v_dot2c_f32_bf16 v31, v210, v210
    v_dot2c_f32_bf16 v30, s55, v211
    v_dot2c_f32_bf16 v31, v211, v211
    s_set_gpr_idx_on s53, gpr_idx(SRC1)
    s_nop 0
    v_lshlrev_b32 v40, 16, v96
    v_and_b32 v41, s54, v96
    v_lshlrev_b32 v42, 16, v97
    v_and_b32 v43, s54, v97
    v_lshlrev_b32 v44, 16, v98
    v_and_b32 v45, s54, v98
    v_lshlrev_b32 v46, 16, v99
    v_and_b32 v47, s54, v99
    s_set_gpr_idx_off
    s_waitcnt vmcnt(7)
    s_xor_b32 s71, s70, 65536
    buffer_load_dwordx4 v[104:107], v19, s[4:7], s71 offen offset:0
    v_dot2c_f32_bf16 v32, s55, v100
    v_dot2c_f32_bf16 v33, v100, v100
    v_dot2c_f32_bf16 v32, s55, v101
    v_dot2c_f32_bf16 v33, v101, v101
    v_dot2c_f32_bf16 v32, s55, v102
    v_dot2c_f32_bf16 v33, v102, v102
    v_dot2c_f32_bf16 v32, s55, v103
    v_dot2c_f32_bf16 v33, v103, v103
    v_add_f32_dpp v30, v30, v30 quad_perm:[1,0,3,2] row_mask:0xf bank_mask:0xf
    v_add_f32_dpp v31, v31, v31 quad_perm:[1,0,3,2] row_mask:0xf bank_mask:0xf
    s_waitcnt vmcnt(7)
    buffer_load_dwordx4 v[120:123], v19, s[4:7], s71 offen offset:128
    v_dot2c_f32_bf16 v32, s55, v116
    v_dot2c_f32_bf16 v33, v116, v116
    v_dot2c_f32_bf16 v32, s55, v117
    v_dot2c_f32_bf16 v33, v117, v117
    v_dot2c_f32_bf16 v32, s55, v118
    v_dot2c_f32_bf16 v33, v118, v118
    v_dot2c_f32_bf16 v32, s55, v119
    v_dot2c_f32_bf16 v33, v119, v119
    v_add_f32_dpp v30, v30, v30 quad_perm:[2,3,0,1] row_mask:0xf bank_mask:0xf
    v_add_f32_dpp v31, v31, v31 quad_perm:[2,3,0,1] row_mask:0xf bank_mask:0xf
    s_waitcnt vmcnt(7)
    buffer_load_dwordx4 v[136:139], v19, s[4:7], s71 offen offset:256
    v_dot2c_f32_bf16 v32, s55, v132
    v_dot2c_f32_bf16 v33, v132, v132
    v_dot2c_f32_bf16 v32, s55, v133
    v_dot2c_f32_bf16 v33, v133, v133
    v_dot2c_f32_bf16 v32, s55, v134
    v_dot2c_f32_bf16 v33, v134, v134
    v_dot2c_f32_bf16 v32, s55, v135
    v_dot2c_f32_bf16 v33, v135, v135
    v_add_f32_dpp v30, v30, v30 row_half_mirror row_mask:0xf bank_mask:0xf
    v_add_f32_dpp v31, v31, v31 row_half_mirror row_mask:0xf bank_mask:0xf
    s_waitcnt vmcnt(7)
    buffer_load_dwordx4 v[152:155], v19, s[4:7], s71 offen offset:384
    v_dot2c_f32_bf16 v32, s55, v148
    v_dot2c_f32_bf16 v33, v148, v148
    v_dot2c_f32_bf16 v32, s55, v149
    v_dot2c_f32_bf16 v33, v149, v149
    v_dot2c_f32_bf16 v32, s55, v150
    v_dot2c_f32_bf16 v33, v150, v150
    v_dot2c_f32_bf16 v32, s55, v151
    v_dot2c_f32_bf16 v33, v151, v151
    v_mul_f32 v30, s32, v30
    v_mul_f32 v31, s32, v31
    v_fma_f32 v31, -v30, v30, v31
    v_max_f32 v31, 0, v31
    v_cvt_pk_bf16_f32 v31, v30, v31
    v_lshlrev_b32 v30, 16, v31
    v_and_b32 v31, s54, v31
    v_add_f32 v31, s33, v31
    v_cvt_pk_bf16_f32 v31, v31, v31
    v_and_b32 v31, s54, v31
    v_sqrt_f32 v31, v31
    s_waitcnt vmcnt(7)
    s_xor_b32 s71, s70, 66048
    buffer_load_dwordx4 v[168:171], v19, s[4:7], s71 offen offset:0
    v_dot2c_f32_bf16 v32, s55, v164
    v_dot2c_f32_bf16 v33, v164, v164
    v_dot2c_f32_bf16 v32, s55, v165
    v_dot2c_f32_bf16 v33, v165, v165
    v_dot2c_f32_bf16 v32, s55, v166
    v_dot2c_f32_bf16 v33, v166, v166
    v_dot2c_f32_bf16 v32, s55, v167
    v_dot2c_f32_bf16 v33, v167, v167
    v_cvt_pk_bf16_f32 v31, v31, v31
    v_and_b32 v31, s54, v31
    v_rcp_f32 v22, v31
    s_waitcnt vmcnt(7)
    buffer_load_dwordx4 v[184:187], v19, s[4:7], s71 offen offset:128
    v_dot2c_f32_bf16 v32, s55, v180
    v_dot2c_f32_bf16 v33, v180, v180
    v_dot2c_f32_bf16 v32, s55, v181
    v_dot2c_f32_bf16 v33, v181, v181
    v_dot2c_f32_bf16 v32, s55, v182
    v_dot2c_f32_bf16 v33, v182, v182
    v_dot2c_f32_bf16 v32, s55, v183
    v_dot2c_f32_bf16 v33, v183, v183
    v_mul_f32_e64 v23, -v30, v22
    v_fma_f32 v40, v40, v22, v23
    v_fma_f32 v41, v41, v22, v23
    v_fma_f32 v42, v42, v22, v23
    v_fma_f32 v43, v43, v22, v23
    v_fma_f32 v44, v44, v22, v23
    v_fma_f32 v45, v45, v22, v23
    v_fma_f32 v46, v46, v22, v23
    v_fma_f32 v47, v47, v22, v23
    v_cvt_pk_bf16_f32 v72, v40, v41
    v_cvt_pk_bf16_f32 v73, v42, v43
    v_cvt_pk_bf16_f32 v74, v44, v45
    v_cvt_pk_bf16_f32 v75, v46, v47
    ds_write_b128 v88, v[72:75]
    v_xor_b32 v88, 16384, v88
    s_waitcnt vmcnt(7)
    buffer_load_dwordx4 v[200:203], v19, s[4:7], s71 offen offset:256
    v_dot2c_f32_bf16 v32, s55, v196
    v_dot2c_f32_bf16 v33, v196, v196
    v_dot2c_f32_bf16 v32, s55, v197
    v_dot2c_f32_bf16 v33, v197, v197
    v_dot2c_f32_bf16 v32, s55, v198
    v_dot2c_f32_bf16 v33, v198, v198
    v_dot2c_f32_bf16 v32, s55, v199
    v_dot2c_f32_bf16 v33, v199, v199
    s_waitcnt vmcnt(7)
    buffer_load_dwordx4 v[216:219], v19, s[4:7], s71 offen offset:384
    s_barrier
    v_dot2c_f32_bf16 v32, s55, v212
    v_dot2c_f32_bf16 v33, v212, v212
    v_dot2c_f32_bf16 v32, s55, v213
    v_dot2c_f32_bf16 v33, v213, v213
    v_dot2c_f32_bf16 v32, s55, v214
    v_dot2c_f32_bf16 v33, v214, v214
    v_dot2c_f32_bf16 v32, s55, v215
    v_dot2c_f32_bf16 v33, v215, v215
    s_set_gpr_idx_on s53, gpr_idx(SRC1)
    s_nop 0
    v_lshlrev_b32 v48, 16, v100
    v_and_b32 v49, s54, v100
    v_lshlrev_b32 v50, 16, v101
    v_and_b32 v51, s54, v101
    v_lshlrev_b32 v52, 16, v102
    v_and_b32 v53, s54, v102
    v_lshlrev_b32 v54, 16, v103
    v_and_b32 v55, s54, v103
    s_set_gpr_idx_off
    s_waitcnt vmcnt(7)
    s_xor_b32 s71, s70, 98304
    buffer_load_dwordx4 v[108:111], v19, s[4:7], s71 offen offset:0
    v_dot2c_f32_bf16 v34, s55, v104
    v_dot2c_f32_bf16 v35, v104, v104
    v_dot2c_f32_bf16 v34, s55, v105
    v_dot2c_f32_bf16 v35, v105, v105
    v_dot2c_f32_bf16 v34, s55, v106
    v_dot2c_f32_bf16 v35, v106, v106
    v_dot2c_f32_bf16 v34, s55, v107
    v_dot2c_f32_bf16 v35, v107, v107
    v_add_f32_dpp v32, v32, v32 quad_perm:[1,0,3,2] row_mask:0xf bank_mask:0xf
    v_add_f32_dpp v33, v33, v33 quad_perm:[1,0,3,2] row_mask:0xf bank_mask:0xf
    s_waitcnt vmcnt(7)
    buffer_load_dwordx4 v[124:127], v19, s[4:7], s71 offen offset:128
    v_dot2c_f32_bf16 v34, s55, v120
    v_dot2c_f32_bf16 v35, v120, v120
    v_dot2c_f32_bf16 v34, s55, v121
    v_dot2c_f32_bf16 v35, v121, v121
    v_dot2c_f32_bf16 v34, s55, v122
    v_dot2c_f32_bf16 v35, v122, v122
    v_dot2c_f32_bf16 v34, s55, v123
    v_dot2c_f32_bf16 v35, v123, v123
    v_add_f32_dpp v32, v32, v32 quad_perm:[2,3,0,1] row_mask:0xf bank_mask:0xf
    v_add_f32_dpp v33, v33, v33 quad_perm:[2,3,0,1] row_mask:0xf bank_mask:0xf
    s_waitcnt vmcnt(7)
    buffer_load_dwordx4 v[140:143], v19, s[4:7], s71 offen offset:256
    v_dot2c_f32_bf16 v34, s55, v136
    v_dot2c_f32_bf16 v35, v136, v136
    v_dot2c_f32_bf16 v34, s55, v137
    v_dot2c_f32_bf16 v35, v137, v137
    v_dot2c_f32_bf16 v34, s55, v138
    v_dot2c_f32_bf16 v35, v138, v138
    v_dot2c_f32_bf16 v34, s55, v139
    v_dot2c_f32_bf16 v35, v139, v139
    v_add_f32_dpp v32, v32, v32 row_half_mirror row_mask:0xf bank_mask:0xf
    v_add_f32_dpp v33, v33, v33 row_half_mirror row_mask:0xf bank_mask:0xf
    s_waitcnt vmcnt(7)
    buffer_load_dwordx4 v[156:159], v19, s[4:7], s71 offen offset:384
    v_dot2c_f32_bf16 v34, s55, v152
    v_dot2c_f32_bf16 v35, v152, v152
    v_dot2c_f32_bf16 v34, s55, v153
    v_dot2c_f32_bf16 v35, v153, v153
    v_dot2c_f32_bf16 v34, s55, v154
    v_dot2c_f32_bf16 v35, v154, v154
    v_dot2c_f32_bf16 v34, s55, v155
    v_dot2c_f32_bf16 v35, v155, v155
    v_mul_f32 v32, s32, v32
    v_mul_f32 v33, s32, v33
    v_fma_f32 v33, -v32, v32, v33
    v_max_f32 v33, 0, v33
    v_cvt_pk_bf16_f32 v33, v32, v33
    v_lshlrev_b32 v32, 16, v33
    v_and_b32 v33, s54, v33
    v_add_f32 v33, s33, v33
    v_cvt_pk_bf16_f32 v33, v33, v33
    v_and_b32 v33, s54, v33
    v_sqrt_f32 v33, v33
    s_waitcnt vmcnt(7)
    s_xor_b32 s71, s70, 98816
    buffer_load_dwordx4 v[172:175], v19, s[4:7], s71 offen offset:0
    v_dot2c_f32_bf16 v34, s55, v168
    v_dot2c_f32_bf16 v35, v168, v168
    v_dot2c_f32_bf16 v34, s55, v169
    v_dot2c_f32_bf16 v35, v169, v169
    v_dot2c_f32_bf16 v34, s55, v170
    v_dot2c_f32_bf16 v35, v170, v170
    v_dot2c_f32_bf16 v34, s55, v171
    v_dot2c_f32_bf16 v35, v171, v171
    v_cvt_pk_bf16_f32 v33, v33, v33
    v_and_b32 v33, s54, v33
    v_rcp_f32 v24, v33
    s_waitcnt vmcnt(7)
    buffer_load_dwordx4 v[188:191], v19, s[4:7], s71 offen offset:128
    v_dot2c_f32_bf16 v34, s55, v184
    v_dot2c_f32_bf16 v35, v184, v184
    v_dot2c_f32_bf16 v34, s55, v185
    v_dot2c_f32_bf16 v35, v185, v185
    v_dot2c_f32_bf16 v34, s55, v186
    v_dot2c_f32_bf16 v35, v186, v186
    v_dot2c_f32_bf16 v34, s55, v187
    v_dot2c_f32_bf16 v35, v187, v187
    v_mul_f32_e64 v25, -v32, v24
    v_fma_f32 v48, v48, v24, v25
    v_fma_f32 v49, v49, v24, v25
    v_fma_f32 v50, v50, v24, v25
    v_fma_f32 v51, v51, v24, v25
    v_fma_f32 v52, v52, v24, v25
    v_fma_f32 v53, v53, v24, v25
    v_fma_f32 v54, v54, v24, v25
    v_fma_f32 v55, v55, v24, v25
    v_cvt_pk_bf16_f32 v76, v48, v49
    v_cvt_pk_bf16_f32 v77, v50, v51
    v_cvt_pk_bf16_f32 v78, v52, v53
    v_cvt_pk_bf16_f32 v79, v54, v55
    ds_write_b128 v89, v[76:79]
    v_xor_b32 v89, 16384, v89
    s_waitcnt vmcnt(7)
    buffer_load_dwordx4 v[204:207], v19, s[4:7], s71 offen offset:256
    v_dot2c_f32_bf16 v34, s55, v200
    v_dot2c_f32_bf16 v35, v200, v200
    v_dot2c_f32_bf16 v34, s55, v201
    v_dot2c_f32_bf16 v35, v201, v201
    v_dot2c_f32_bf16 v34, s55, v202
    v_dot2c_f32_bf16 v35, v202, v202
    v_dot2c_f32_bf16 v34, s55, v203
    v_dot2c_f32_bf16 v35, v203, v203
    s_waitcnt vmcnt(7)
    buffer_load_dwordx4 v[220:223], v19, s[4:7], s71 offen offset:384
    s_barrier
    v_dot2c_f32_bf16 v34, s55, v216
    v_dot2c_f32_bf16 v35, v216, v216
    v_dot2c_f32_bf16 v34, s55, v217
    v_dot2c_f32_bf16 v35, v217, v217
    v_dot2c_f32_bf16 v34, s55, v218
    v_dot2c_f32_bf16 v35, v218, v218
    v_dot2c_f32_bf16 v34, s55, v219
    v_dot2c_f32_bf16 v35, v219, v219
    s_set_gpr_idx_on s53, gpr_idx(SRC1)
    s_nop 0
    v_lshlrev_b32 v56, 16, v104
    v_and_b32 v57, s54, v104
    v_lshlrev_b32 v58, 16, v105
    v_and_b32 v59, s54, v105
    v_lshlrev_b32 v60, 16, v106
    v_and_b32 v61, s54, v106
    v_lshlrev_b32 v62, 16, v107
    v_and_b32 v63, s54, v107
    s_set_gpr_idx_off
    s_waitcnt vmcnt(7)
    v_dot2c_f32_bf16 v36, s55, v108
    v_dot2c_f32_bf16 v37, v108, v108
    v_dot2c_f32_bf16 v36, s55, v109
    v_dot2c_f32_bf16 v37, v109, v109
    v_dot2c_f32_bf16 v36, s55, v110
    v_dot2c_f32_bf16 v37, v110, v110
    v_dot2c_f32_bf16 v36, s55, v111
    v_dot2c_f32_bf16 v37, v111, v111
    v_add_f32_dpp v34, v34, v34 quad_perm:[1,0,3,2] row_mask:0xf bank_mask:0xf
    v_add_f32_dpp v35, v35, v35 quad_perm:[1,0,3,2] row_mask:0xf bank_mask:0xf
    s_waitcnt vmcnt(6)
    v_dot2c_f32_bf16 v36, s55, v124
    v_dot2c_f32_bf16 v37, v124, v124
    v_dot2c_f32_bf16 v36, s55, v125
    v_dot2c_f32_bf16 v37, v125, v125
    v_dot2c_f32_bf16 v36, s55, v126
    v_dot2c_f32_bf16 v37, v126, v126
    v_dot2c_f32_bf16 v36, s55, v127
    v_dot2c_f32_bf16 v37, v127, v127
    v_add_f32_dpp v34, v34, v34 quad_perm:[2,3,0,1] row_mask:0xf bank_mask:0xf
    v_add_f32_dpp v35, v35, v35 quad_perm:[2,3,0,1] row_mask:0xf bank_mask:0xf
    s_waitcnt vmcnt(5)
    v_dot2c_f32_bf16 v36, s55, v140
    v_dot2c_f32_bf16 v37, v140, v140
    v_dot2c_f32_bf16 v36, s55, v141
    v_dot2c_f32_bf16 v37, v141, v141
    v_dot2c_f32_bf16 v36, s55, v142
    v_dot2c_f32_bf16 v37, v142, v142
    v_dot2c_f32_bf16 v36, s55, v143
    v_dot2c_f32_bf16 v37, v143, v143
    v_add_f32_dpp v34, v34, v34 row_half_mirror row_mask:0xf bank_mask:0xf
    v_add_f32_dpp v35, v35, v35 row_half_mirror row_mask:0xf bank_mask:0xf
    s_waitcnt vmcnt(4)
    v_dot2c_f32_bf16 v36, s55, v156
    v_dot2c_f32_bf16 v37, v156, v156
    v_dot2c_f32_bf16 v36, s55, v157
    v_dot2c_f32_bf16 v37, v157, v157
    v_dot2c_f32_bf16 v36, s55, v158
    v_dot2c_f32_bf16 v37, v158, v158
    v_dot2c_f32_bf16 v36, s55, v159
    v_dot2c_f32_bf16 v37, v159, v159
    v_mul_f32 v34, s32, v34
    v_mul_f32 v35, s32, v35
    v_fma_f32 v35, -v34, v34, v35
    v_max_f32 v35, 0, v35
    v_cvt_pk_bf16_f32 v35, v34, v35
    v_lshlrev_b32 v34, 16, v35
    v_and_b32 v35, s54, v35
    v_add_f32 v35, s33, v35
    v_cvt_pk_bf16_f32 v35, v35, v35
    v_and_b32 v35, s54, v35
    v_sqrt_f32 v35, v35
    s_waitcnt vmcnt(3)
    v_dot2c_f32_bf16 v36, s55, v172
    v_dot2c_f32_bf16 v37, v172, v172
    v_dot2c_f32_bf16 v36, s55, v173
    v_dot2c_f32_bf16 v37, v173, v173
    v_dot2c_f32_bf16 v36, s55, v174
    v_dot2c_f32_bf16 v37, v174, v174
    v_dot2c_f32_bf16 v36, s55, v175
    v_dot2c_f32_bf16 v37, v175, v175
    v_cvt_pk_bf16_f32 v35, v35, v35
    v_and_b32 v35, s54, v35
    v_rcp_f32 v26, v35
    s_waitcnt vmcnt(2)
    v_dot2c_f32_bf16 v36, s55, v188
    v_dot2c_f32_bf16 v37, v188, v188
    v_dot2c_f32_bf16 v36, s55, v189
    v_dot2c_f32_bf16 v37, v189, v189
    v_dot2c_f32_bf16 v36, s55, v190
    v_dot2c_f32_bf16 v37, v190, v190
    v_dot2c_f32_bf16 v36, s55, v191
    v_dot2c_f32_bf16 v37, v191, v191
    v_mul_f32_e64 v27, -v34, v26
    v_fma_f32 v56, v56, v26, v27
    v_fma_f32 v57, v57, v26, v27
    v_fma_f32 v58, v58, v26, v27
    v_fma_f32 v59, v59, v26, v27
    v_fma_f32 v60, v60, v26, v27
    v_fma_f32 v61, v61, v26, v27
    v_fma_f32 v62, v62, v26, v27
    v_fma_f32 v63, v63, v26, v27
    v_cvt_pk_bf16_f32 v80, v56, v57
    v_cvt_pk_bf16_f32 v81, v58, v59
    v_cvt_pk_bf16_f32 v82, v60, v61
    v_cvt_pk_bf16_f32 v83, v62, v63
    ds_write_b128 v90, v[80:83]
    v_xor_b32 v90, 16384, v90
    s_waitcnt vmcnt(1)
    v_dot2c_f32_bf16 v36, s55, v204
    v_dot2c_f32_bf16 v37, v204, v204
    v_dot2c_f32_bf16 v36, s55, v205
    v_dot2c_f32_bf16 v37, v205, v205
    v_dot2c_f32_bf16 v36, s55, v206
    v_dot2c_f32_bf16 v37, v206, v206
    v_dot2c_f32_bf16 v36, s55, v207
    v_dot2c_f32_bf16 v37, v207, v207
    s_waitcnt vmcnt(0)
    v_dot2c_f32_bf16 v36, s55, v220
    v_dot2c_f32_bf16 v37, v220, v220
    v_dot2c_f32_bf16 v36, s55, v221
    v_dot2c_f32_bf16 v37, v221, v221
    v_dot2c_f32_bf16 v36, s55, v222
    v_dot2c_f32_bf16 v37, v222, v222
    v_dot2c_f32_bf16 v36, s55, v223
    v_dot2c_f32_bf16 v37, v223, v223
    s_set_gpr_idx_on s53, gpr_idx(SRC1)
    s_nop 0
    v_lshlrev_b32 v64, 16, v108
    v_and_b32 v65, s54, v108
    v_lshlrev_b32 v66, 16, v109
    v_and_b32 v67, s54, v109
    v_lshlrev_b32 v68, 16, v110
    v_and_b32 v69, s54, v110
    v_lshlrev_b32 v70, 16, v111
    v_and_b32 v71, s54, v111
    s_set_gpr_idx_off
    v_add_f32_dpp v36, v36, v36 quad_perm:[1,0,3,2] row_mask:0xf bank_mask:0xf
    v_add_f32_dpp v37, v37, v37 quad_perm:[1,0,3,2] row_mask:0xf bank_mask:0xf
    s_nop 0
    v_add_f32_dpp v36, v36, v36 quad_perm:[2,3,0,1] row_mask:0xf bank_mask:0xf
    v_add_f32_dpp v37, v37, v37 quad_perm:[2,3,0,1] row_mask:0xf bank_mask:0xf
    s_nop 0
    v_add_f32_dpp v36, v36, v36 row_half_mirror row_mask:0xf bank_mask:0xf
    v_add_f32_dpp v37, v37, v37 row_half_mirror row_mask:0xf bank_mask:0xf
    s_nop 0
    v_mul_f32 v36, s32, v36
    v_mul_f32 v37, s32, v37
    v_fma_f32 v37, -v36, v36, v37
    v_max_f32 v37, 0, v37
    v_cvt_pk_bf16_f32 v37, v36, v37
    v_lshlrev_b32 v36, 16, v37
    v_and_b32 v37, s54, v37
    v_add_f32 v37, s33, v37
    v_cvt_pk_bf16_f32 v37, v37, v37
    v_and_b32 v37, s54, v37
    v_sqrt_f32 v37, v37
    s_nop 0
    v_cvt_pk_bf16_f32 v37, v37, v37
    v_and_b32 v37, s54, v37
    v_rcp_f32 v28, v37
    s_nop 0
    v_mul_f32_e64 v29, -v36, v28
    v_fma_f32 v64, v64, v28, v29
    v_fma_f32 v65, v65, v28, v29
    v_fma_f32 v66, v66, v28, v29
    v_fma_f32 v67, v67, v28, v29
    v_fma_f32 v68, v68, v28, v29
    v_fma_f32 v69, v69, v28, v29
    v_fma_f32 v70, v70, v28, v29
    v_fma_f32 v71, v71, v28, v29
    v_cvt_pk_bf16_f32 v84, v64, v65
    v_cvt_pk_bf16_f32 v85, v66, v67
    v_cvt_pk_bf16_f32 v86, v68, v69
    v_cvt_pk_bf16_f32 v87, v70, v71
    ds_write_b128 v91, v[84:87]
    v_xor_b32 v91, 16384, v91
    s_xor_b32 s79, s79, 16384
    s_add_u32 s53, s53, 16
    s_and_b32 s53, s53, 127
    s_setprio 0
    s_waitcnt lgkmcnt(0)
    s_barrier
    s_add_u32 m0, s48, 5120
    s_add_u32 s50, s49, s51
    buffer_load_dwordx4 v15, s[8:11], s50 offen  lds
    s_add_u32 m0, s48, 6144
    s_nop 0
    buffer_load_dwordx4 v16, s[8:11], s50 offen  lds
    s_add_u32 m0, s48, 7168
    s_nop 0
    buffer_load_dwordx4 v17, s[8:11], s50 offen  lds
    s_add_u32 m0, s48, 8192
    s_nop 0
    buffer_load_dwordx4 v18, s[8:11], s50 offen  lds
K1_pw1:
    s_add_u32 s49, s49, s59
    s_add_u32 s57, s57, 1
    s_cmp_eq_u32 s49, s73
    s_cselect_b32 s49, 0, s49
    s_cmp_eq_u32 s57, 3
    s_cselect_b32 s61, 4294893312, s62
    s_cselect_b32 s57, 0, s57
    s_add_u32 s48, s48, s61
K1_PROD_loop:
    s_add_u32 m0, s48, 0
    s_add_u32 s50, s49, s51
    buffer_load_dwordx4 v10, s[8:11], s50 offen  lds
    s_set_gpr_idx_on s53, gpr_idx(SRC1)
    s_nop 0
    v_lshlrev_b32 v40, 16, v96
    v_and_b32 v41, s54, v96
    v_lshlrev_b32 v42, 16, v97
    v_and_b32 v43, s54, v97
    v_lshlrev_b32 v44, 16, v98
    v_and_b32 v45, s54, v98
    v_lshlrev_b32 v46, 16, v99
    v_and_b32 v47, s54, v99
    s_set_gpr_idx_off
    s_add_u32 m0, s48, 1024
    v_fma_f32 v40, v40, v22, v23
    buffer_load_dwordx4 v11, s[8:11], s50 offen  lds
    v_fma_f32 v41, v41, v22, v23
    v_fma_f32 v42, v42, v22, v23
    v_fma_f32 v43, v43, v22, v23
    v_fma_f32 v44, v44, v22, v23
    v_fma_f32 v45, v45, v22, v23
    v_fma_f32 v46, v46, v22, v23
    v_fma_f32 v47, v47, v22, v23
    v_cvt_pk_bf16_f32 v72, v40, v41
    v_cvt_pk_bf16_f32 v73, v42, v43
    v_cvt_pk_bf16_f32 v74, v44, v45
    v_cvt_pk_bf16_f32 v75, v46, v47
    ds_write_b128 v88, v[72:75]
    v_xor_b32 v88, 16384, v88
    s_add_u32 m0, s48, 2048
    s_nop 0
    buffer_load_dwordx4 v12, s[8:11], s50 offen  lds
    s_set_gpr_idx_on s53, gpr_idx(SRC1)
    s_nop 0
    v_lshlrev_b32 v48, 16, v100
    v_and_b32 v49, s54, v100
    v_lshlrev_b32 v50, 16, v101
    v_and_b32 v51, s54, v101
    v_lshlrev_b32 v52, 16, v102
    v_and_b32 v53, s54, v102
    v_lshlrev_b32 v54, 16, v103
    v_and_b32 v55, s54, v103
    s_set_gpr_idx_off
    s_add_u32 m0, s48, 3072
    v_fma_f32 v48, v48, v24, v25
    buffer_load_dwordx4 v13, s[8:11], s50 offen  lds
    v_fma_f32 v49, v49, v24, v25
    v_fma_f32 v50, v50, v24, v25
    v_fma_f32 v51, v51, v24, v25
    v_fma_f32 v52, v52, v24, v25
    v_fma_f32 v53, v53, v24, v25
    v_fma_f32 v54, v54, v24, v25
    v_fma_f32 v55, v55, v24, v25
    v_cvt_pk_bf16_f32 v76, v48, v49
    v_cvt_pk_bf16_f32 v77, v50, v51
    v_cvt_pk_bf16_f32 v78, v52, v53
    v_cvt_pk_bf16_f32 v79, v54, v55
    ds_write_b128 v89, v[76:79]
    v_xor_b32 v89, 16384, v89
    s_add_u32 m0, s48, 4096
    s_nop 0
    buffer_load_dwordx4 v14, s[8:11], s50 offen  lds
    s_set_gpr_idx_on s53, gpr_idx(SRC1)
    s_nop 0
    v_lshlrev_b32 v56, 16, v104
    v_and_b32 v57, s54, v104
    v_lshlrev_b32 v58, 16, v105
    v_and_b32 v59, s54, v105
    v_lshlrev_b32 v60, 16, v106
    v_and_b32 v61, s54, v106
    v_lshlrev_b32 v62, 16, v107
    v_and_b32 v63, s54, v107
    s_set_gpr_idx_off
    s_add_u32 m0, s48, 5120
    s_add_u32 s50, s49, s51
    v_fma_f32 v56, v56, v26, v27
    buffer_load_dwordx4 v15, s[8:11], s50 offen  lds
    v_fma_f32 v57, v57, v26, v27
    v_fma_f32 v58, v58, v26, v27
    v_fma_f32 v59, v59, v26, v27
    v_fma_f32 v60, v60, v26, v27
    v_fma_f32 v61, v61, v26, v27
    v_fma_f32 v62, v62, v26, v27
    v_fma_f32 v63, v63, v26, v27
    v_cvt_pk_bf16_f32 v80, v56, v57
    v_cvt_pk_bf16_f32 v81, v58, v59
    v_cvt_pk_bf16_f32 v82, v60, v61
    v_cvt_pk_bf16_f32 v83, v62, v63
    ds_write_b128 v90, v[80:83]
    v_xor_b32 v90, 16384, v90
    s_add_u32 m0, s48, 6144
    s_nop 0
    buffer_load_dwordx4 v16, s[8:11], s50 offen  lds
    s_set_gpr_idx_on s53, gpr_idx(SRC1)
    s_nop 0
    v_lshlrev_b32 v64, 16, v108
    v_and_b32 v65, s54, v108
    v_lshlrev_b32 v66, 16, v109
    v_and_b32 v67, s54, v109
    v_lshlrev_b32 v68, 16, v110
    v_and_b32 v69, s54, v110
    v_lshlrev_b32 v70, 16, v111
    v_and_b32 v71, s54, v111
    s_set_gpr_idx_off
    s_add_u32 m0, s48, 7168
    v_fma_f32 v64, v64, v28, v29
    buffer_load_dwordx4 v17, s[8:11], s50 offen  lds
    v_fma_f32 v65, v65, v28, v29
    v_fma_f32 v66, v66, v28, v29
    v_fma_f32 v67, v67, v28, v29
    v_fma_f32 v68, v68, v28, v29
    v_fma_f32 v69, v69, v28, v29
    v_fma_f32 v70, v70, v28, v29
    v_fma_f32 v71, v71, v28, v29
    v_cvt_pk_bf16_f32 v84, v64, v65
    v_cvt_pk_bf16_f32 v85, v66, v67
    v_cvt_pk_bf16_f32 v86, v68, v69
    v_cvt_pk_bf16_f32 v87, v70, v71
    ds_write_b128 v91, v[84:87]
    v_xor_b32 v91, 16384, v91
    s_add_u32 m0, s48, 8192
    s_xor_b32 s79, s79, 16384
    buffer_load_dwordx4 v18, s[8:11], s50 offen  lds
    s_add_u32 s53, s53, 16
    s_and_b32 s53, s53, 127
    s_add_u32 s49, s49, s59
    s_add_u32 s57, s57, 1
    s_cmp_eq_u32 s49, s73
    s_cselect_b32 s49, 0, s49
    s_cmp_eq_u32 s57, 3
    s_cselect_b32 s61, 4294893312, s62
    s_cselect_b32 s57, 0, s57
    s_add_u32 s48, s48, s61
    s_add_u32 s47, s47, 1
    s_waitcnt vmcnt(9) lgkmcnt(0)
    s_barrier
    s_cmp_lt_u32 s47, 6
    s_cbranch_scc1 K1_PROD_loop
    buffer_load_dword v2, off, s[24:27], 0 sc0 sc1
    s_mov_b64 s[8:9], s[30:31]
    s_add_u32 s10, s88, 4096
    buffer_load_dword v20, v20, s[8:11], s88 offen
    s_add_u32 s66, s68, 0
    s_sub_u32 s69, s66, 1409024
    s_cselect_b32 s66, s66, s69
    s_add_u32 m0, s64, 110592
    s_nop 0
    buffer_load_dwordx4 v21, s[16:19], s66 offen lds
    s_set_gpr_idx_on s53, gpr_idx(SRC1)
    s_nop 0
    v_lshlrev_b32 v40, 16, v96
    v_and_b32 v41, s54, v96
    v_lshlrev_b32 v42, 16, v97
    v_and_b32 v43, s54, v97
    v_lshlrev_b32 v44, 16, v98
    v_and_b32 v45, s54, v98
    v_lshlrev_b32 v46, 16, v99
    v_and_b32 v47, s54, v99
    s_set_gpr_idx_off
    s_add_u32 s66, s68, 32768
    s_sub_u32 s69, s66, 1409024
    s_cselect_b32 s66, s66, s69
    s_add_u32 m0, s64, 114688
    v_fma_f32 v40, v40, v22, v23
    buffer_load_dwordx4 v21, s[16:19], s66 offen lds
    v_fma_f32 v41, v41, v22, v23
    v_fma_f32 v42, v42, v22, v23
    v_fma_f32 v43, v43, v22, v23
    v_fma_f32 v44, v44, v22, v23
    v_fma_f32 v45, v45, v22, v23
    v_fma_f32 v46, v46, v22, v23
    v_fma_f32 v47, v47, v22, v23
    v_cvt_pk_bf16_f32 v72, v40, v41
    v_cvt_pk_bf16_f32 v73, v42, v43
    v_cvt_pk_bf16_f32 v74, v44, v45
    v_cvt_pk_bf16_f32 v75, v46, v47
    ds_write_b128 v88, v[72:75]
    v_xor_b32 v88, 16384, v88
    s_add_u32 s66, s68, 65536
    s_sub_u32 s69, s66, 1409024
    s_cselect_b32 s66, s66, s69
    s_add_u32 m0, s64, 118784
    s_nop 0
    buffer_load_dwordx4 v21, s[16:19], s66 offen lds
    s_set_gpr_idx_on s53, gpr_idx(SRC1)
    s_nop 0
    v_lshlrev_b32 v48, 16, v100
    v_and_b32 v49, s54, v100
    v_lshlrev_b32 v50, 16, v101
    v_and_b32 v51, s54, v101
    v_lshlrev_b32 v52, 16, v102
    v_and_b32 v53, s54, v102
    v_lshlrev_b32 v54, 16, v103
    v_and_b32 v55, s54, v103
    s_set_gpr_idx_off
    s_add_u32 s66, s68, 98304
    s_sub_u32 s69, s66, 1409024
    s_cselect_b32 s66, s66, s69
    s_add_u32 m0, s64, 122880
    v_fma_f32 v48, v48, v24, v25
    buffer_load_dwordx4 v21, s[16:19], s66 offen lds
    v_fma_f32 v49, v49, v24, v25
    v_fma_f32 v50, v50, v24, v25
    v_fma_f32 v51, v51, v24, v25
    v_fma_f32 v52, v52, v24, v25
    v_fma_f32 v53, v53, v24, v25
    v_fma_f32 v54, v54, v24, v25
    v_fma_f32 v55, v55, v24, v25
    v_cvt_pk_bf16_f32 v76, v48, v49
    v_cvt_pk_bf16_f32 v77, v50, v51
    v_cvt_pk_bf16_f32 v78, v52, v53
    v_cvt_pk_bf16_f32 v79, v54, v55
    ds_write_b128 v89, v[76:79]
    v_xor_b32 v89, 16384, v89
    s_add_u32 s66, s68, 704512
    s_sub_u32 s69, s66, 1409024
    s_cselect_b32 s66, s66, s69
    s_add_u32 m0, s64, 126976
    s_nop 0
    buffer_load_dwordx4 v21, s[16:19], s66 offen lds
    s_set_gpr_idx_on s53, gpr_idx(SRC1)
    s_nop 0
    v_lshlrev_b32 v56, 16, v104
    v_and_b32 v57, s54, v104
    v_lshlrev_b32 v58, 16, v105
    v_and_b32 v59, s54, v105
    v_lshlrev_b32 v60, 16, v106
    v_and_b32 v61, s54, v106
    v_lshlrev_b32 v62, 16, v107
    v_and_b32 v63, s54, v107
    s_set_gpr_idx_off
    s_add_u32 s66, s68, 737280
    s_sub_u32 s69, s66, 1409024
    s_cselect_b32 s66, s66, s69
    s_add_u32 m0, s64, 131072
    v_fma_f32 v56, v56, v26, v27
    buffer_load_dwordx4 v21, s[16:19], s66 offen lds
    v_fma_f32 v57, v57, v26, v27
    v_fma_f32 v58, v58, v26, v27
    v_fma_f32 v59, v59, v26, v27
    v_fma_f32 v60, v60, v26, v27
    v_fma_f32 v61, v61, v26, v27
    v_fma_f32 v62, v62, v26, v27
    v_fma_f32 v63, v63, v26, v27
    v_cvt_pk_bf16_f32 v80, v56, v57
    v_cvt_pk_bf16_f32 v81, v58, v59
    v_cvt_pk_bf16_f32 v82, v60, v61
    v_cvt_pk_bf16_f32 v83, v62, v63
    ds_write_b128 v90, v[80:83]
    v_xor_b32 v90, 16384, v90
    s_add_u32 s66, s68, 770048
    s_sub_u32 s69, s66, 1409024
    s_cselect_b32 s66, s66, s69
    s_add_u32 m0, s64, 135168
    s_nop 0
    buffer_load_dwordx4 v21, s[16:19], s66 offen lds
    s_set_gpr_idx_on s53, gpr_idx(SRC1)
    s_nop 0
    v_lshlrev_b32 v64, 16, v108
    v_and_b32 v65, s54, v108
    v_lshlrev_b32 v66, 16, v109
    v_and_b32 v67, s54, v109
    v_lshlrev_b32 v68, 16, v110
    v_and_b32 v69, s54, v110
    v_lshlrev_b32 v70, 16, v111
    v_and_b32 v71, s54, v111
    s_set_gpr_idx_off
    s_add_u32 s66, s68, 802816
    s_sub_u32 s69, s66, 1409024
    s_cselect_b32 s66, s66, s69
    s_add_u32 m0, s64, 139264
    v_fma_f32 v64, v64, v28, v29
    buffer_load_dwordx4 v21, s[16:19], s66 offen lds
    v_fma_f32 v65, v65, v28, v29
    v_fma_f32 v66, v66, v28, v29
    v_fma_f32 v67, v67, v28, v29
    v_fma_f32 v68, v68, v28, v29
    v_fma_f32 v69, v69, v28, v29
    v_fma_f32 v70, v70, v28, v29
    v_fma_f32 v71, v71, v28, v29
    v_cvt_pk_bf16_f32 v84, v64, v65
    v_cvt_pk_bf16_f32 v85, v66, v67
    v_cvt_pk_bf16_f32 v86, v68, v69
    v_cvt_pk_bf16_f32 v87, v70, v71
    ds_write_b128 v91, v[84:87]
    v_xor_b32 v91, 16384, v91
    s_xor_b32 s79, s79, 16384
    s_add_u32 s53, s53, 16
    s_and_b32 s53, s53, 127
    s_waitcnt vmcnt(9) lgkmcnt(0)
    s_setprio 0
    s_barrier
    s_mov_b32 s90, 0
K1_zpoll:
    v_readfirstlane_b32 s66, v2
    s_cmp_ge_u32 s66, 16
    s_cbranch_scc1 K1_zdone
    s_sleep 4
    buffer_load_dword v2, off, s[24:27], 0 sc0 sc1
    s_add_u32 s90, s90, 1
    s_cmp_lt_u32 s90, 0x100000
    s_waitcnt vmcnt(0)
    s_cbranch_scc1 K1_zpoll
K1_zdone:
    s_add_u32 s66, s68, 131072
    s_sub_u32 s69, s66, 1409024
    s_cselect_b32 s66, s66, s69
    s_add_u32 m0, s64, 32768
    s_nop 0
    buffer_load_dwordx4 v21, s[16:19], s66 offen lds
    s_add_u32 s66, s68, 163840
    s_sub_u32 s69, s66, 1409024
    s_cselect_b32 s66, s66, s69
    s_add_u32 m0, s64, 36864
    s_nop 0
    buffer_load_dwordx4 v21, s[16:19], s66 offen lds
    s_add_u32 s66, s68, 196608
    s_sub_u32 s69, s66, 1409024
    s_cselect_b32 s66, s66, s69
    s_add_u32 m0, s64, 40960
    s_nop 0
    buffer_load_dwordx4 v21, s[16:19], s66 offen lds
    s_add_u32 s66, s68, 229376
    s_sub_u32 s69, s66, 1409024
    s_cselect_b32 s66, s66, s69
    s_add_u32 m0, s64, 45056
    s_nop 0
    buffer_load_dwordx4 v21, s[16:19], s66 offen lds
    s_add_u32 s66, s68, 262144
    s_mul_i32 s69, s42, 557056
    s_add_u32 s66, s66, s69
    s_sub_u32 s69, s66, 1409024
    s_cselect_b32 s66, s66, s69
    s_add_u32 m0, s64, 49152
    s_nop 0
    buffer_load_dwordx4 v21, s[16:19], s66 offen lds
    s_add_u32 s66, s68, 851968
    s_sub_u32 s69, s66, 1409024
    s_cselect_b32 s66, s66, s69
    s_add_u32 m0, s64, 53248
    s_nop 0
    buffer_load_dwordx4 v21, s[16:19], s66 offen lds
    s_add_u32 s66, s68, 884736
    s_sub_u32 s69, s66, 1409024
    s_cselect_b32 s66, s66, s69
    s_add_u32 m0, s64, 57344
    s_nop 0
    buffer_load_dwordx4 v21, s[16:19], s66 offen lds
    s_add_u32 s66, s68, 917504
    s_sub_u32 s69, s66, 1409024
    s_cselect_b32 s66, s66, s69
    s_add_u32 m0, s64, 61440
    s_nop 0
    buffer_load_dwordx4 v21, s[16:19], s66 offen lds
    s_add_u32 s66, s68, 950272
    s_sub_u32 s69, s66, 1409024
    s_cselect_b32 s66, s66, s69
    s_add_u32 m0, s64, 65536
    s_nop 0
    buffer_load_dwordx4 v21, s[16:19], s66 offen lds
    s_barrier
    v_mov_b32 v27, 144000
    v_mov_b32 v7, 1
    s_add_u32 m0, s64, 0
    s_xor_b32 s66, s65, 0
    buffer_load_dwordx4 v21, s[12:15], s66 offen lds
    s_add_u32 m0, s64, 4096
    s_xor_b32 s66, s65, 8192
    buffer_load_dwordx4 v21, s[12:15], s66 offen lds
    s_add_u32 m0, s64, 8192
    s_xor_b32 s66, s65, 16384
    buffer_load_dwordx4 v21, s[12:15], s66 offen lds
    s_add_u32 m0, s64, 12288
    s_xor_b32 s66, s65, 24576
    buffer_load_dwordx4 v21, s[12:15], s66 offen lds
    s_add_u32 m0, s64, 16384
    s_xor_b32 s66, s65, 32768
    buffer_load_dwordx4 v21, s[12:15], s66 offen lds
    s_add_u32 m0, s64, 20480
    s_xor_b32 s66, s65, 40960
    buffer_load_dwordx4 v21, s[12:15], s66 offen lds
    s_add_u32 m0, s64, 24576
    s_xor_b32 s66, s65, 49152
    buffer_load_dwordx4 v21, s[12:15], s66 offen lds
    s_add_u32 m0, s64, 28672
    s_xor_b32 s66, s65, 57344
    buffer_load_dwordx4 v21, s[12:15], s66 offen lds
    s_add_u32 m0, s64, 73728
    s_xor_b32 s66, s65, 65536
    buffer_load_dwordx4 v21, s[12:15], s66 offen lds
    s_add_u32 m0, s64, 77824
    s_xor_b32 s66, s65, 73728
    buffer_load_dwordx4 v21, s[12:15], s66 offen lds
    s_add_u32 m0, s64, 81920
    s_xor_b32 s66, s65, 81920
    buffer_load_dwordx4 v21, s[12:15], s66 offen lds
    s_add_u32 m0, s64, 86016
    s_xor_b32 s66, s65, 90112
    buffer_load_dwordx4 v21, s[12:15], s66 offen lds
    s_add_u32 m0, s64, 90112
    s_xor_b32 s66, s65, 98304
    buffer_load_dwordx4 v21, s[12:15], s66 offen lds
    s_add_u32 m0, s64, 94208
    s_xor_b32 s66, s65, 106496
    buffer_load_dwordx4 v21, s[12:15], s66 offen lds
    s_add_u32 m0, s64, 98304
    s_xor_b32 s66, s65, 114688
    buffer_load_dwordx4 v21, s[12:15], s66 offen lds
    s_add_u32 m0, s64, 102400
    s_xor_b32 s66, s65, 122880
    buffer_load_dwordx4 v21, s[12:15], s66 offen lds
    s_add_u32 s66, s68, 278528
    s_sub_u32 s69, s66, 1409024
    s_cselect_b32 s66, s66, s69
    s_add_u32 m0, s64, 69632
    s_nop 0
    buffer_load_dwordx4 v21, s[16:19], s66 offen lds
    s_add_u32 s66, s68, 983040
    s_sub_u32 s69, s66, 1409024
    s_cselect_b32 s66, s66, s69
    s_add_u32 m0, s64, 106496
    s_nop 0
    buffer_load_dwordx4 v21, s[16:19], s66 offen lds
    s_add_u32 s66, s68, 311296
    s_sub_u32 s69, s66, 1409024
    s_cselect_b32 s66, s66, s69
    s_add_u32 m0, s64, 147456
    s_nop 0
    buffer_load_dwordx4 v21, s[16:19], s66 offen lds
    s_add_u32 s66, s68, 344064
    s_sub_u32 s69, s66, 1409024
    s_cselect_b32 s66, s66, s69
    s_add_u32 m0, s64, 151552
    s_nop 0
    buffer_load_dwordx4 v21, s[16:19], s66 offen lds
    s_add_u32 s66, s68, 1015808
    s_sub_u32 s69, s66, 1409024
    s_cselect_b32 s66, s66, s69
    s_add_u32 m0, s64, 155648
    s_nop 0
    buffer_load_dwordx4 v21, s[16:19], s66 offen lds
    s_add_u32 s66, s68, 1048576
    s_sub_u32 s69, s66, 1409024
    s_cselect_b32 s66, s66, s69
    s_add_u32 m0, s64, 159744
    s_nop 0
    buffer_load_dwordx4 v21, s[16:19], s66 offen lds
    s_waitcnt vmcnt(14)
    s_mov_b64 exec, 1
    ds_add_u32 v27, v7 offset:4
    s_mov_b64 exec, -1
    ds_read_b64_tr_b16 v[124:125], v92 offset:0
    ds_read_b64_tr_b16 v[126:127], v92 offset:4096
    ds_read_b64_tr_b16 v[128:129], v93 offset:0
    ds_read_b64_tr_b16 v[130:131], v93 offset:4096
    ds_read_b64_tr_b16 v[132:133], v92 offset:8192
    ds_read_b64_tr_b16 v[134:135], v92 offset:12288
    ds_read_b64_tr_b16 v[136:137], v93 offset:8192
    ds_read_b64_tr_b16 v[138:139], v93 offset:12288
    ds_read_b64_tr_b16 v[140:141], v92 offset:16384
    ds_read_b64_tr_b16 v[142:143], v92 offset:20480
    ds_read_b64_tr_b16 v[144:145], v93 offset:16384
    ds_read_b64_tr_b16 v[146:147], v93 offset:20480
    ds_read_b64_tr_b16 v[148:149], v92 offset:24576
    ds_read_b64_tr_b16 v[150:151], v92 offset:28672
    ds_read_b64_tr_b16 v[152:153], v93 offset:24576
    ds_read_b64_tr_b16 v[154:155], v93 offset:28672
    s_waitcnt lgkmcnt(0)
    v_add_u32 v92, 73728, v92
    v_add_u32 v93, 73728, v93
    s_waitcnt vmcnt(6)
    ds_read_b64_tr_b16 v[156:157], v92 offset:0
    ds_read_b64_tr_b16 v[158:159], v92 offset:4096
    ds_read_b64_tr_b16 v[160:161], v93 offset:0
    ds_read_b64_tr_b16 v[162:163], v93 offset:4096
    ds_read_b64_tr_b16 v[164:165], v92 offset:8192
    ds_read_b64_tr_b16 v[166:167], v92 offset:12288
    ds_read_b64_tr_b16 v[168:169], v93 offset:8192
    ds_read_b64_tr_b16 v[170:171], v93 offset:12288
    ds_read_b64_tr_b16 v[172:173], v92 offset:16384
    ds_read_b64_tr_b16 v[174:175], v92 offset:20480
    ds_read_b64_tr_b16 v[176:177], v93 offset:16384
    ds_read_b64_tr_b16 v[178:179], v93 offset:20480
    ds_read_b64_tr_b16 v[180:181], v92 offset:24576
    ds_read_b64_tr_b16 v[182:183], v92 offset:28672
    ds_read_b64_tr_b16 v[184:185], v93 offset:24576
    ds_read_b64_tr_b16 v[186:187], v93 offset:28672
    s_waitcnt lgkmcnt(0)
    v_lshlrev_b32 v10, 4, v1
    s_mul_i32 s3, s74, 236
    s_lshl_b32 s65, s52, 3
    s_add_u32 s3, s3, s65
    s_add_u32 s3, s3, 86
    s_lshl_b32 s70, s3, 10
    s_lshl_b32 s65, s76, 12
    s_xor_b32 s3, s65, 4096
    s_add_u32 s67, s70, s3
    s_add_u32 s70, s70, s65
    s_add_u32 s72, s70, 120832
    s_add_u32 s73, s67, 120832
    s_mul_i32 s66, s41, 120832
    s_add_u32 s70, s70, s66
    s_add_u32 s67, s67, s66
    s_sub_u32 s72, s72, s66
    s_sub_u32 s73, s73, s66
    s_lshl_b32 s4, s52, 13
    s_add_u32 s4, s4, 8388608
    s_add_u32 s5, s4, s3
    s_add_u32 s4, s4, s65
    s_lshl_b32 s6, s52, 9
    s_add_u32 s6, s6, 8421376
    v_lshrrev_b32 v3, 4, v1
    v_xor_b32 v3, 1, v3
    v_lshlrev_b32 v3, 4, v3
    v_and_b32 v4, 15, v1
    v_lshl_add_u32 v11, v4, 6, v3
    v_and_b32 v4, 3, v1
    v_lshl_add_u32 v14, v4, 6, v3
    v_bfe_u32 v4, v1, 3, 1
    v_xor_b32 v4, s76, v4
    v_lshl_add_u32 v14, v4, 8, v14
    s_lshr_b32 s71, s74, 1
    s_lshl_b32 s71, s71, 11
    s_add_u32 s71, s71, 8454144
    s_mov_b32 s89, 0x358637bd
    s_mov_b32 s90, 0
    v_lshrrev_b32 v3, 2, v1
    v_and_b32 v5, 3, v1
    v_lshl_add_u32 v3, v3, 4, v5
    v_lshlrev_b32 v3, 7, v3
    v_and_b32 v4, 15, v1
    v_lshlrev_b32 v4, 7, v4
    s_mov_b32 s88, 8455424
    v_lshrrev_b32 v5, 3, v1
    v_and_b32 v6, 7, v1
    v_xor_b32 v6, v6, v5
    v_lshlrev_b32 v5, 10, v5
    v_lshl_add_u32 v15, v6, 4, v5
    s_mov_b32 s12, s92
    s_mov_b32 s13, s93
    s_mov_b32 s14, 2097152
    s_mov_b32 s15, 0x00020000
    s_lshl2_add_u32 s77, s74, s52
    s_lshl_b32 s77, s77, 14
    s_lshl_b32 s3, s75, 7
    s_add_u32 s77, s77, s3
    s_waitcnt vmcnt(0)
    s_barrier
    s_setprio 1
    s_add_u32 s66, s68, 376832
    s_sub_u32 s69, s66, 1409024
    s_cselect_b32 s66, s66, s69
    s_add_u32 m0, s64, 0
    s_nop 0
    buffer_load_dwordx4 v21, s[16:19], s66 offen lds
    s_add_u32 s66, s68, 1081344
    s_sub_u32 s69, s66, 1409024
    s_cselect_b32 s66, s66, s69
    s_add_u32 m0, s64, 73728
    s_nop 0
    buffer_load_dwordx4 v21, s[16:19], s66 offen lds
    s_add_u32 s66, s68, 409600
    s_sub_u32 s69, s66, 1409024
    s_cselect_b32 s66, s66, s69
    s_add_u32 m0, s64, 4096
    s_nop 0
    buffer_load_dwordx4 v21, s[16:19], s66 offen lds
    s_add_u32 s66, s68, 1114112
    s_sub_u32 s69, s66, 1409024
    s_cselect_b32 s66, s66, s69
    s_add_u32 m0, s64, 77824
    s_nop 0
    buffer_load_dwordx4 v21, s[16:19], s66 offen lds
    s_add_u32 s66, s68, 442368
    s_sub_u32 s69, s66, 1409024
    s_cselect_b32 s66, s66, s69
    s_add_u32 m0, s64, 8192
    s_nop 0
    buffer_load_dwordx4 v21, s[16:19], s66 offen lds
    s_add_u32 s66, s68, 1146880
    s_sub_u32 s69, s66, 1409024
    s_cselect_b32 s66, s66, s69
    s_add_u32 m0, s64, 81920
    s_nop 0
    buffer_load_dwordx4 v21, s[16:19], s66 offen lds
    s_add_u32 s66, s68, 475136
    s_sub_u32 s69, s66, 1409024
    s_cselect_b32 s66, s66, s69
    s_add_u32 m0, s64, 12288
    s_nop 0
    buffer_load_dwordx4 v21, s[16:19], s66 offen lds
    s_add_u32 s66, s68, 1179648
    s_sub_u32 s69, s66, 1409024
    s_cselect_b32 s66, s66, s69
    s_add_u32 m0, s64, 86016
    s_nop 0
    buffer_load_dwordx4 v21, s[16:19], s66 offen lds
    s_add_u32 s66, s68, 507904
    s_sub_u32 s69, s66, 1409024
    s_cselect_b32 s66, s66, s69
    s_add_u32 m0, s64, 16384
    s_nop 0
    buffer_load_dwordx4 v21, s[16:19], s66 offen lds
    s_add_u32 s66, s68, 1212416
    s_sub_u32 s69, s66, 1409024
    s_cselect_b32 s66, s66, s69
    s_add_u32 m0, s64, 90112
    s_nop 0
    buffer_load_dwordx4 v21, s[16:19], s66 offen lds
    s_add_u32 s66, s68, 540672
    s_sub_u32 s69, s66, 1409024
    s_cselect_b32 s66, s66, s69
    s_add_u32 m0, s64, 20480
    s_nop 0
    buffer_load_dwordx4 v21, s[16:19], s66 offen lds
    s_add_u32 s66, s68, 1245184
    s_sub_u32 s69, s66, 1409024
    s_cselect_b32 s66, s66, s69
    s_add_u32 m0, s64, 94208
    s_nop 0
    buffer_load_dwordx4 v21, s[16:19], s66 offen lds
    s_add_u32 s66, s68, 573440
    s_sub_u32 s69, s66, 1409024
    s_cselect_b32 s66, s66, s69
    s_add_u32 m0, s64, 24576
    s_nop 0
    buffer_load_dwordx4 v21, s[16:19], s66 offen lds
    s_add_u32 s66, s68, 1277952
    s_sub_u32 s69, s66, 1409024
    s_cselect_b32 s66, s66, s69
    s_add_u32 m0, s64, 98304
    s_nop 0
    buffer_load_dwordx4 v21, s[16:19], s66 offen lds
    s_add_u32 s66, s68, 606208
    s_sub_u32 s69, s66, 1409024
    s_cselect_b32 s66, s66, s69
    s_add_u32 m0, s64, 28672
    s_nop 0
    buffer_load_dwordx4 v21, s[16:19], s66 offen lds
    s_add_u32 s66, s68, 1310720
    s_sub_u32 s69, s66, 1409024
    s_cselect_b32 s66, s66, s69
    s_add_u32 m0, s64, 102400
    s_nop 0
    buffer_load_dwordx4 v21, s[16:19], s66 offen lds
    s_add_u32 s66, s68, 638976
    s_sub_u32 s69, s66, 1409024
    s_cselect_b32 s66, s66, s69
    s_add_u32 m0, s64, 110592
    s_nop 0
    buffer_load_dwordx4 v21, s[16:19], s66 offen lds
    s_add_u32 s66, s68, 1343488
    s_sub_u32 s69, s66, 1409024
    s_cselect_b32 s66, s66, s69
    s_add_u32 m0, s64, 126976
    s_nop 0
    buffer_load_dwordx4 v21, s[16:19], s66 offen lds
    s_add_u32 s66, s68, 671744
    s_sub_u32 s69, s66, 1409024
    s_cselect_b32 s66, s66, s69
    s_add_u32 m0, s64, 114688
    s_nop 0
    buffer_load_dwordx4 v21, s[16:19], s66 offen lds
    s_add_u32 s66, s68, 1376256
    s_sub_u32 s69, s66, 1409024
    s_cselect_b32 s66, s66, s69
    s_add_u32 m0, s64, 131072
    s_nop 0
    buffer_load_dwordx4 v21, s[16:19], s66 offen lds
    s_cmp_eq_u32 s40, 4
    s_cbranch_scc1 K2_p4
    s_waitcnt vmcnt(4)
    s_mov_b64 exec, 1
    ds_add_u32 v27, v7 offset:12
    s_mov_b64 exec, -1
    s_branch K2_swait
K2_p4:
    buffer_load_dword v2, v4, s[20:23], s71 offen sc0 sc1
    buffer_load_dword v5, v3, s[20:23], s88 offen sc0 sc1
    s_waitcnt vmcnt(6)
    s_mov_b64 exec, 1
    ds_add_u32 v27, v7 offset:12
    s_mov_b64 exec, -1
    s_waitcnt vmcnt(1)
    v_cmp_ne_u32 vcc, 0, v2
    s_and_b32 s66, vcc_lo, 0x3ff
    s_cmp_eq_u32 s66, 0x3ff
    s_cselect_b32 s66, 1, 2
    s_mov_b64 exec, 1
    v_mov_b32 v6, s66
    ds_write_b32 v27, v6 offset:16
    s_mov_b64 exec, -1
K2_spoll:
    s_add_u32 s90, s90, 1
    s_waitcnt vmcnt(0)
    v_cmp_ne_u32 vcc, 0, v2
    s_or_b32 s66, vcc_lo, 0xffff3fff
    v_cmp_ne_u32 vcc, 0, v5
    s_and_b32 s66, s66, vcc_lo
    s_and_b32 s66, s66, vcc_hi
    s_cmp_eq_u32 s66, -1
    s_cbranch_scc1 K2_sset
    s_sleep 3
    buffer_load_dword v2, v4, s[20:23], s71 offen sc0 sc1
    buffer_load_dword v5, v3, s[20:23], s88 offen sc0 sc1
    s_cmp_lt_u32 s90, 0x100000
    s_cbranch_scc1 K2_spoll
K2_sset:
    s_mov_b64 exec, 1
    ds_add_u32 v27, v7 offset:20
    s_mov_b64 exec, -1
K2_swait:
K_lws:
    s_sleep 1
    ds_read_b32 v6, v27 offset:20
    s_waitcnt lgkmcnt(0)
    v_readfirstlane_b32 s66, v6
    s_cmp_lt_u32 s66, 1
    s_cbranch_scc1 K_lws
    s_setprio 1
    buffer_load_dwordx4 v[16:19], v14, s[20:23], s6 offen sc0 sc1
    buffer_load_dwordx4 v[108:111], v11, s[20:23], s4 offen offset:0 sc0 sc1
    buffer_load_dwordx4 v[76:79], v10, s[20:23], s70 offen offset:0 sc0 sc1
    buffer_load_dwordx4 v[80:83], v10, s[20:23], s72 offen offset:0 sc0 sc1
    buffer_load_dwordx4 v[112:115], v11, s[20:23], s4 offen offset:1024 sc0 sc1
    buffer_load_dwordx4 v[84:87], v10, s[20:23], s70 offen offset:1024 sc0 sc1
    buffer_load_dwordx4 v[88:91], v10, s[20:23], s72 offen offset:1024 sc0 sc1
    buffer_load_dwordx4 v[116:119], v11, s[20:23], s4 offen offset:2048 sc0 sc1
    buffer_load_dwordx4 v[92:95], v10, s[20:23], s70 offen offset:2048 sc0 sc1
    buffer_load_dwordx4 v[96:99], v10, s[20:23], s72 offen offset:2048 sc0 sc1
    s_waitcnt vmcnt(8)
    v_cvt_pk_bf16_f32 v16, v16, v17
    v_cvt_pk_bf16_f32 v17, v18, v19
    v_cvt_pk_bf16_f32 v28, v108, v109
    v_cvt_pk_bf16_f32 v29, v110, v111
    v_mov_b32 v30, v16
    v_mov_b32 v31, v17
    s_nop 0
    v_permlane16_swap_b32 v30, v28
    v_permlane16_swap_b32 v31, v29
    s_waitcnt vmcnt(6)
    s_nop 0
    v_mfma_f32_32x32x16_bf16 v[44:59], v[28:31], v[76:79], 0
    v_mfma_f32_32x32x16_bf16 v[60:75], v[28:31], v[80:83], 0
    buffer_load_dwordx4 v[120:123], v11, s[20:23], s4 offen offset:3072 sc0 sc1
    buffer_load_dwordx4 v[100:103], v10, s[20:23], s70 offen offset:3072 sc0 sc1
    buffer_load_dwordx4 v[104:107], v10, s[20:23], s72 offen offset:3072 sc0 sc1
    s_waitcnt vmcnt(8)
    v_cvt_pk_bf16_f32 v32, v112, v113
    v_cvt_pk_bf16_f32 v33, v114, v115
    v_mov_b32 v34, v16
    v_mov_b32 v35, v17
    s_nop 0
    v_permlane16_swap_b32 v34, v32
    v_permlane16_swap_b32 v35, v33
    v_add_f32 v44, s89, v44
    v_rcp_f32 v44, v44
    s_nop 0
    v_mul_f32 v52, v44, v52
    v_mul_f32 v53, v44, v53
    v_mul_f32 v54, v44, v54
    v_mul_f32 v55, v44, v55
    v_mul_f32 v56, v44, v56
    v_mul_f32 v57, v44, v57
    v_mul_f32 v58, v44, v58
    v_mul_f32 v59, v44, v59
    v_cvt_pk_bf16_f32 v36, v52, v53
    v_cvt_pk_bf16_f32 v37, v54, v55
    v_cvt_pk_bf16_f32 v38, v56, v57
    v_cvt_pk_bf16_f32 v39, v58, v59
    s_waitcnt vmcnt(6)
    v_mfma_f32_32x32x16_bf16 v[44:59], v[32:35], v[84:87], 0
    v_add_f32 v60, s89, v60
    v_rcp_f32 v60, v60
    s_nop 0
    v_mul_f32 v68, v60, v68
    v_mfma_f32_32x32x16_bf16 v[188:203], v[124:127], v[36:39], 0
    v_mul_f32 v69, v60, v69
    v_mul_f32 v70, v60, v70
    v_mul_f32 v71, v60, v71
    v_mul_f32 v72, v60, v72
    v_mul_f32 v73, v60, v73
    v_mul_f32 v74, v60, v74
    v_mfma_f32_32x32x16_bf16 v[204:219], v[128:131], v[36:39], 0
    v_mul_f32 v75, v60, v75
    v_cvt_pk_bf16_f32 v40, v68, v69
    v_cvt_pk_bf16_f32 v41, v70, v71
    v_cvt_pk_bf16_f32 v42, v72, v73
    v_cvt_pk_bf16_f32 v43, v74, v75
    v_mfma_f32_32x32x16_bf16 v[60:75], v[32:35], v[88:91], 0
    buffer_load_dwordx4 v[108:111], v11, s[20:23], s5 offen offset:0 sc0 sc1
    buffer_load_dwordx4 v[76:79], v10, s[20:23], s67 offen offset:0 sc0 sc1
    buffer_load_dwordx4 v[80:83], v10, s[20:23], s73 offen offset:0 sc0 sc1
    v_add_f32 v45, s89, v45
    v_rcp_f32 v45, v45
    s_nop 0
    v_mul_f32 v52, v45, v52
    v_mfma_f32_32x32x16_bf16 v[220:235], v[124:127], v[40:43], 0
    v_mul_f32 v53, v45, v53
    v_mul_f32 v54, v45, v54
    v_mul_f32 v55, v45, v55
    v_mul_f32 v56, v45, v56
    v_mul_f32 v57, v45, v57
    v_mul_f32 v58, v45, v58
    v_mfma_f32_32x32x16_bf16 v[236:251], v[128:131], v[40:43], 0
    s_waitcnt vmcnt(8)
    v_cvt_pk_bf16_f32 v28, v116, v117
    v_cvt_pk_bf16_f32 v29, v118, v119
    v_mov_b32 v30, v16
    v_mov_b32 v31, v17
    s_nop 0
    v_permlane16_swap_b32 v30, v28
    v_permlane16_swap_b32 v31, v29
    v_mul_f32 v59, v45, v59
    v_cvt_pk_bf16_f32 v36, v52, v53
    v_cvt_pk_bf16_f32 v37, v54, v55
    v_cvt_pk_bf16_f32 v38, v56, v57
    v_cvt_pk_bf16_f32 v39, v58, v59
    s_waitcnt vmcnt(6)
    v_mfma_f32_32x32x16_bf16 v[44:59], v[28:31], v[92:95], 0
    v_add_f32 v61, s89, v61
    v_rcp_f32 v61, v61
    s_nop 0
    v_mul_f32 v68, v61, v68
    v_mfma_f32_32x32x16_bf16 v[188:203], v[132:135], v[36:39], v[188:203]
    v_mul_f32 v69, v61, v69
    v_mul_f32 v70, v61, v70
    v_mul_f32 v71, v61, v71
    v_mul_f32 v72, v61, v72
    v_mul_f32 v73, v61, v73
    v_mul_f32 v74, v61, v74
    v_mfma_f32_32x32x16_bf16 v[204:219], v[136:139], v[36:39], v[204:219]
    v_mul_f32 v75, v61, v75
    v_cvt_pk_bf16_f32 v40, v68, v69
    v_cvt_pk_bf16_f32 v41, v70, v71
    v_cvt_pk_bf16_f32 v42, v72, v73
    v_cvt_pk_bf16_f32 v43, v74, v75
    v_mfma_f32_32x32x16_bf16 v[60:75], v[28:31], v[96:99], 0
    buffer_load_dwordx4 v[112:115], v11, s[20:23], s5 offen offset:1024 sc0 sc1
    buffer_load_dwordx4 v[84:87], v10, s[20:23], s67 offen offset:1024 sc0 sc1
    buffer_load_dwordx4 v[88:91], v10, s[20:23], s73 offen offset:1024 sc0 sc1
    v_add_f32 v46, s89, v46
    v_rcp_f32 v46, v46
    s_nop 0
    v_mul_f32 v52, v46, v52
    v_mfma_f32_32x32x16_bf16 v[220:235], v[132:135], v[40:43], v[220:235]
    v_mul_f32 v53, v46, v53
    v_mul_f32 v54, v46, v54
    v_mul_f32 v55, v46, v55
    v_mul_f32 v56, v46, v56
    v_mul_f32 v57, v46, v57
    v_mul_f32 v58, v46, v58
    v_mfma_f32_32x32x16_bf16 v[236:251], v[136:139], v[40:43], v[236:251]
    s_waitcnt vmcnt(8)
    v_cvt_pk_bf16_f32 v32, v120, v121
    v_cvt_pk_bf16_f32 v33, v122, v123
    v_mov_b32 v34, v16
    v_mov_b32 v35, v17
    s_nop 0
    v_permlane16_swap_b32 v34, v32
    v_permlane16_swap_b32 v35, v33
    v_mul_f32 v59, v46, v59
    v_cvt_pk_bf16_f32 v36, v52, v53
    v_cvt_pk_bf16_f32 v37, v54, v55
    v_cvt_pk_bf16_f32 v38, v56, v57
    v_cvt_pk_bf16_f32 v39, v58, v59
    s_waitcnt vmcnt(6)
    v_mfma_f32_32x32x16_bf16 v[44:59], v[32:35], v[100:103], 0
    v_add_f32 v62, s89, v62
    v_rcp_f32 v62, v62
    s_nop 0
    v_mul_f32 v68, v62, v68
    v_mfma_f32_32x32x16_bf16 v[188:203], v[140:143], v[36:39], v[188:203]
    v_mul_f32 v69, v62, v69
    v_mul_f32 v70, v62, v70
    v_mul_f32 v71, v62, v71
    v_mul_f32 v72, v62, v72
    v_mul_f32 v73, v62, v73
    v_mul_f32 v74, v62, v74
    v_mfma_f32_32x32x16_bf16 v[204:219], v[144:147], v[36:39], v[204:219]
    v_mul_f32 v75, v62, v75
    v_cvt_pk_bf16_f32 v40, v68, v69
    v_cvt_pk_bf16_f32 v41, v70, v71
    v_cvt_pk_bf16_f32 v42, v72, v73
    v_cvt_pk_bf16_f32 v43, v74, v75
    v_mfma_f32_32x32x16_bf16 v[60:75], v[32:35], v[104:107], 0
    buffer_load_dwordx4 v[116:119], v11, s[20:23], s5 offen offset:2048 sc0 sc1
    buffer_load_dwordx4 v[92:95], v10, s[20:23], s67 offen offset:2048 sc0 sc1
    buffer_load_dwordx4 v[96:99], v10, s[20:23], s73 offen offset:2048 sc0 sc1
    v_add_f32 v47, s89, v47
    v_rcp_f32 v47, v47
    s_nop 0
    v_mul_f32 v52, v47, v52
    v_mfma_f32_32x32x16_bf16 v[220:235], v[140:143], v[40:43], v[220:235]
    v_mul_f32 v53, v47, v53
    v_mul_f32 v54, v47, v54
    v_mul_f32 v55, v47, v55
    v_mul_f32 v56, v47, v56
    v_mul_f32 v57, v47, v57
    v_mul_f32 v58, v47, v58
    v_mfma_f32_32x32x16_bf16 v[236:251], v[144:147], v[40:43], v[236:251]
    s_waitcnt vmcnt(8)
    v_cvt_pk_bf16_f32 v28, v108, v109
    v_cvt_pk_bf16_f32 v29, v110, v111
    v_mov_b32 v30, v16
    v_mov_b32 v31, v17
    s_nop 0
    v_permlane16_swap_b32 v30, v28
    v_permlane16_swap_b32 v31, v29
    v_mul_f32 v59, v47, v59
    v_cvt_pk_bf16_f32 v36, v52, v53
    v_cvt_pk_bf16_f32 v37, v54, v55
    v_cvt_pk_bf16_f32 v38, v56, v57
    v_cvt_pk_bf16_f32 v39, v58, v59
    s_waitcnt vmcnt(6)
    v_mfma_f32_32x32x16_bf16 v[44:59], v[28:31], v[76:79], 0
    v_add_f32 v63, s89, v63
    v_rcp_f32 v63, v63
    s_nop 0
    v_mul_f32 v68, v63, v68
    v_mfma_f32_32x32x16_bf16 v[188:203], v[148:151], v[36:39], v[188:203]
    v_mul_f32 v69, v63, v69
    v_mul_f32 v70, v63, v70
    v_mul_f32 v71, v63, v71
    v_mul_f32 v72, v63, v72
    v_mul_f32 v73, v63, v73
    v_mul_f32 v74, v63, v74
    v_mfma_f32_32x32x16_bf16 v[204:219], v[152:155], v[36:39], v[204:219]
    v_mul_f32 v75, v63, v75
    v_cvt_pk_bf16_f32 v40, v68, v69
    v_cvt_pk_bf16_f32 v41, v70, v71
    v_cvt_pk_bf16_f32 v42, v72, v73
    v_cvt_pk_bf16_f32 v43, v74, v75
    v_mfma_f32_32x32x16_bf16 v[60:75], v[28:31], v[80:83], 0
    buffer_load_dwordx4 v[120:123], v11, s[20:23], s5 offen offset:3072 sc0 sc1
    buffer_load_dwordx4 v[100:103], v10, s[20:23], s67 offen offset:3072 sc0 sc1
    buffer_load_dwordx4 v[104:107], v10, s[20:23], s73 offen offset:3072 sc0 sc1
    v_add_f32 v48, s89, v48
    v_rcp_f32 v48, v48
    s_nop 0
    v_mul_f32 v52, v48, v52
    v_mfma_f32_32x32x16_bf16 v[220:235], v[148:151], v[40:43], v[220:235]
    v_mul_f32 v53, v48, v53
    v_mul_f32 v54, v48, v54
    v_mul_f32 v55, v48, v55
    v_mul_f32 v56, v48, v56
    v_mul_f32 v57, v48, v57
    v_mul_f32 v58, v48, v58
    v_mfma_f32_32x32x16_bf16 v[236:251], v[152:155], v[40:43], v[236:251]
    s_waitcnt vmcnt(8)
    v_cvt_pk_bf16_f32 v32, v112, v113
    v_cvt_pk_bf16_f32 v33, v114, v115
    v_mov_b32 v34, v16
    v_mov_b32 v35, v17
    s_nop 0
    v_permlane16_swap_b32 v34, v32
    v_permlane16_swap_b32 v35, v33
    v_mul_f32 v59, v48, v59
    v_cvt_pk_bf16_f32 v36, v52, v53
    v_cvt_pk_bf16_f32 v37, v54, v55
    v_cvt_pk_bf16_f32 v38, v56, v57
    v_cvt_pk_bf16_f32 v39, v58, v59
    s_waitcnt vmcnt(6)
    v_mfma_f32_32x32x16_bf16 v[44:59], v[32:35], v[84:87], 0
    v_add_f32 v64, s89, v64
    v_rcp_f32 v64, v64
    s_nop 0
    v_mul_f32 v68, v64, v68
    v_mfma_f32_32x32x16_bf16 v[188:203], v[156:159], v[36:39], v[188:203]
    v_mul_f32 v69, v64, v69
    v_mul_f32 v70, v64, v70
    v_mul_f32 v71, v64, v71
    v_mul_f32 v72, v64, v72
    v_mul_f32 v73, v64, v73
    v_mul_f32 v74, v64, v74
    v_mfma_f32_32x32x16_bf16 v[204:219], v[160:163], v[36:39], v[204:219]
    v_mul_f32 v75, v64, v75
    v_cvt_pk_bf16_f32 v40, v68, v69
    v_cvt_pk_bf16_f32 v41, v70, v71
    v_cvt_pk_bf16_f32 v42, v72, v73
    v_cvt_pk_bf16_f32 v43, v74, v75
    v_mfma_f32_32x32x16_bf16 v[60:75], v[32:35], v[88:91], 0
    v_add_f32 v49, s89, v49
    v_rcp_f32 v49, v49
    s_nop 0
    v_mul_f32 v52, v49, v52
    v_mfma_f32_32x32x16_bf16 v[220:235], v[156:159], v[40:43], v[220:235]
    v_mul_f32 v53, v49, v53
    v_mul_f32 v54, v49, v54
    v_mul_f32 v55, v49, v55
    v_mul_f32 v56, v49, v56
    v_mul_f32 v57, v49, v57
    v_mul_f32 v58, v49, v58
    v_mfma_f32_32x32x16_bf16 v[236:251], v[160:163], v[40:43], v[236:251]
    s_waitcnt vmcnt(5)
    v_cvt_pk_bf16_f32 v28, v116, v117
    v_cvt_pk_bf16_f32 v29, v118, v119
    v_mov_b32 v30, v16
    v_mov_b32 v31, v17
    s_nop 0
    v_permlane16_swap_b32 v30, v28
    v_permlane16_swap_b32 v31, v29
    v_mul_f32 v59, v49, v59
    v_cvt_pk_bf16_f32 v36, v52, v53
    v_cvt_pk_bf16_f32 v37, v54, v55
    v_cvt_pk_bf16_f32 v38, v56, v57
    v_cvt_pk_bf16_f32 v39, v58, v59
    s_waitcnt vmcnt(3)
    v_mfma_f32_32x32x16_bf16 v[44:59], v[28:31], v[92:95], 0
    v_add_f32 v65, s89, v65
    v_rcp_f32 v65, v65
    s_nop 0
    v_mul_f32 v68, v65, v68
    v_mfma_f32_32x32x16_bf16 v[188:203], v[164:167], v[36:39], v[188:203]
    v_mul_f32 v69, v65, v69
    v_mul_f32 v70, v65, v70
    v_mul_f32 v71, v65, v71
    v_mul_f32 v72, v65, v72
    v_mul_f32 v73, v65, v73
    v_mul_f32 v74, v65, v74
    v_mfma_f32_32x32x16_bf16 v[204:219], v[168:171], v[36:39], v[204:219]
    v_mul_f32 v75, v65, v75
    v_cvt_pk_bf16_f32 v40, v68, v69
    v_cvt_pk_bf16_f32 v41, v70, v71
    v_cvt_pk_bf16_f32 v42, v72, v73
    v_cvt_pk_bf16_f32 v43, v74, v75
    v_mfma_f32_32x32x16_bf16 v[60:75], v[28:31], v[96:99], 0
    v_add_f32 v50, s89, v50
    v_rcp_f32 v50, v50
    s_nop 0
    v_mul_f32 v52, v50, v52
    v_mfma_f32_32x32x16_bf16 v[220:235], v[164:167], v[40:43], v[220:235]
    v_mul_f32 v53, v50, v53
    v_mul_f32 v54, v50, v54
    v_mul_f32 v55, v50, v55
    v_mul_f32 v56, v50, v56
    v_mul_f32 v57, v50, v57
    v_mul_f32 v58, v50, v58
    v_mfma_f32_32x32x16_bf16 v[236:251], v[168:171], v[40:43], v[236:251]
    s_waitcnt vmcnt(2)
    v_cvt_pk_bf16_f32 v32, v120, v121
    v_cvt_pk_bf16_f32 v33, v122, v123
    v_mov_b32 v34, v16
    v_mov_b32 v35, v17
    s_nop 0
    v_permlane16_swap_b32 v34, v32
    v_permlane16_swap_b32 v35, v33
    v_mul_f32 v59, v50, v59
    v_cvt_pk_bf16_f32 v36, v52, v53
    v_cvt_pk_bf16_f32 v37, v54, v55
    v_cvt_pk_bf16_f32 v38, v56, v57
    v_cvt_pk_bf16_f32 v39, v58, v59
    s_waitcnt vmcnt(0)
    v_mfma_f32_32x32x16_bf16 v[44:59], v[32:35], v[100:103], 0
    v_add_f32 v66, s89, v66
    v_rcp_f32 v66, v66
    s_nop 0
    v_mul_f32 v68, v66, v68
    v_mfma_f32_32x32x16_bf16 v[188:203], v[172:175], v[36:39], v[188:203]
    v_mul_f32 v69, v66, v69
    v_mul_f32 v70, v66, v70
    v_mul_f32 v71, v66, v71
    v_mul_f32 v72, v66, v72
    v_mul_f32 v73, v66, v73
    v_mul_f32 v74, v66, v74
    v_mfma_f32_32x32x16_bf16 v[204:219], v[176:179], v[36:39], v[204:219]
    v_mul_f32 v75, v66, v75
    v_cvt_pk_bf16_f32 v40, v68, v69
    v_cvt_pk_bf16_f32 v41, v70, v71
    v_cvt_pk_bf16_f32 v42, v72, v73
    v_cvt_pk_bf16_f32 v43, v74, v75
    v_mfma_f32_32x32x16_bf16 v[60:75], v[32:35], v[104:107], 0
    v_add_f32 v51, s89, v51
    v_rcp_f32 v51, v51
    s_nop 0
    v_mul_f32 v52, v51, v52
    v_mfma_f32_32x32x16_bf16 v[220:235], v[172:175], v[40:43], v[220:235]
    v_mul_f32 v53, v51, v53
    v_mul_f32 v54, v51, v54
    v_mul_f32 v55, v51, v55
    v_mul_f32 v56, v51, v56
    v_mul_f32 v57, v51, v57
    v_mul_f32 v58, v51, v58
    v_mfma_f32_32x32x16_bf16 v[236:251], v[176:179], v[40:43], v[236:251]
    v_mul_f32 v59, v51, v59
    v_cvt_pk_bf16_f32 v36, v52, v53
    v_cvt_pk_bf16_f32 v37, v54, v55
    v_cvt_pk_bf16_f32 v38, v56, v57
    v_cvt_pk_bf16_f32 v39, v58, v59
    s_nop 0
    v_add_f32 v67, s89, v67
    v_rcp_f32 v67, v67
    s_nop 0
    v_mul_f32 v68, v67, v68
    v_mfma_f32_32x32x16_bf16 v[188:203], v[180:183], v[36:39], v[188:203]
    v_mul_f32 v69, v67, v69
    v_mul_f32 v70, v67, v70
    v_mul_f32 v71, v67, v71
    v_mul_f32 v72, v67, v72
    v_mul_f32 v73, v67, v73
    v_mul_f32 v74, v67, v74
    v_mfma_f32_32x32x16_bf16 v[204:219], v[184:187], v[36:39], v[204:219]
    v_mul_f32 v75, v67, v75
    v_cvt_pk_bf16_f32 v40, v68, v69
    v_cvt_pk_bf16_f32 v41, v70, v71
    v_cvt_pk_bf16_f32 v42, v72, v73
    v_cvt_pk_bf16_f32 v43, v74, v75
    s_nop 0
    s_nop 0
    v_mfma_f32_32x32x16_bf16 v[220:235], v[180:183], v[40:43], v[220:235]
    v_mfma_f32_32x32x16_bf16 v[236:251], v[184:187], v[40:43], v[236:251]
K2_sdone:
    v_lshrrev_b32 v5, 3, v0
    v_and_b32 v6, 7, v0
    v_lshlrev_b32 v182, 10, v5
    v_lshl_add_u32 v182, v6, 4, v182
    s_lshl_b32 s77, s74, 16
    s_lshl_b32 s3, s75, 7
    s_add_u32 s77, s77, s3
    s_mov_b32 s16, s92
    s_mov_b32 s17, s93
    s_mov_b32 s18, 2097152
    s_mov_b32 s19, 0x00020000
    buffer_load_dwordx4 v[184:187], v182, s[16:19], s77 offen
    s_mov_b32 s16, s86
    s_mov_b32 s17, s87
    s_mov_b32 s18, 2097152
    s_mov_b32 s19, 0x00020000
    s_lshl_b32 s3, s52, 13
    s_add_u32 s3, s3, 32768
    v_add_u32 v4, s3, v10
    v_xor_b32 v2, 0x4000, v4
    v_xor_b32 v3, 0x2000, v4
    v_xor_b32 v9, 0x6000, v4
    v_cvt_pk_bf16_f32 v76, v204, v205
    v_cvt_pk_bf16_f32 v77, v206, v207
    v_cvt_pk_bf16_f32 v78, v208, v209
    v_cvt_pk_bf16_f32 v79, v210, v211
    v_cvt_pk_bf16_f32 v80, v212, v213
    v_cvt_pk_bf16_f32 v81, v214, v215
    v_cvt_pk_bf16_f32 v82, v216, v217
    v_cvt_pk_bf16_f32 v83, v218, v219
    v_cvt_pk_bf16_f32 v84, v220, v221
    v_cvt_pk_bf16_f32 v85, v222, v223
    v_cvt_pk_bf16_f32 v86, v224, v225
    v_cvt_pk_bf16_f32 v87, v226, v227
    v_cvt_pk_bf16_f32 v88, v228, v229
    v_cvt_pk_bf16_f32 v89, v230, v231
    v_cvt_pk_bf16_f32 v90, v232, v233
    v_cvt_pk_bf16_f32 v91, v234, v235
    v_cvt_pk_bf16_f32 v92, v236, v237
    v_cvt_pk_bf16_f32 v93, v238, v239
    v_cvt_pk_bf16_f32 v94, v240, v241
    v_cvt_pk_bf16_f32 v95, v242, v243
    v_cvt_pk_bf16_f32 v96, v244, v245
    v_cvt_pk_bf16_f32 v97, v246, v247
    v_cvt_pk_bf16_f32 v98, v248, v249
    v_cvt_pk_bf16_f32 v99, v250, v251
    s_barrier
    ds_write_b128 v2, v[76:79] offset:0
    ds_write_b128 v2, v[80:83] offset:1024
    ds_write_b128 v3, v[84:87] offset:2048
    ds_write_b128 v3, v[88:91] offset:3072
    ds_write_b128 v9, v[92:95] offset:4096
    ds_write_b128 v9, v[96:99] offset:5120
    s_lshl_b32 s65, s41, 13
    s_add_u32 s65, s65, 147456
    v_lshrrev_b32 v5, 3, v0
    v_and_b32 v6, 7, v0
    v_lshlrev_b32 v6, 1, v6
    v_and_b32 v8, 15, v5
    v_xor_b32 v6, v6, v8
    v_lshlrev_b32 v5, 8, v5
    v_lshl_add_u32 v176, v6, 4, v5
    v_xor_b32 v177, 16, v176
    v_add_u32 v178, 73728, v176
    v_add_u32 v179, 73728, v177
    v_add_u32 v180, 147456, v176
    v_add_u32 v181, 147456, v177
    v_and_b32 v5, 31, v1
    v_lshrrev_b32 v6, 5, v1
    v_lshl_add_u32 v6, s42, 3, v6
    v_and_b32 v8, 15, v1
    v_xor_b32 v6, v6, v8
    v_lshl_add_u32 v5, v5, 8, s65
    v_lshl_add_u32 v160, v6, 4, v5
    v_xor_b32 v161, 32, v160
    v_xor_b32 v162, 64, v160
    v_xor_b32 v163, 96, v160
    s_mov_b32 s68, 0xbfb8aa3b
    s_waitcnt vmcnt(0) lgkmcnt(0)
    s_mov_b64 exec, 1
    ds_add_u32 v27, v7 offset:28
    s_mov_b64 exec, -1
K_lwz2:
    ds_read_b32 v6, v27 offset:28
    s_waitcnt lgkmcnt(0)
    v_readfirstlane_b32 s66, v6
    s_cmp_lt_u32 s66, 4
    s_cbranch_scc1 K_lwz2
    s_setprio 1
    ds_read_b128 v[124:127], v4 offset:0
    ds_read_b128 v[128:131], v4 offset:1024
    ds_read_b128 v[132:135], v4 offset:2048
    ds_read_b128 v[136:139], v4 offset:3072
    ds_read_b128 v[140:143], v4 offset:4096
    ds_read_b128 v[144:147], v4 offset:5120
    s_waitcnt lgkmcnt(4)
    v_lshlrev_b32 v204, 16, v124
    v_and_b32 v205, s54, v124
    v_lshlrev_b32 v206, 16, v125
    v_and_b32 v207, s54, v125
    v_lshlrev_b32 v208, 16, v126
    v_and_b32 v209, s54, v126
    v_lshlrev_b32 v210, 16, v127
    v_and_b32 v211, s54, v127
    v_lshlrev_b32 v212, 16, v128
    v_and_b32 v213, s54, v128
    v_lshlrev_b32 v214, 16, v129
    v_and_b32 v215, s54, v129
    v_lshlrev_b32 v216, 16, v130
    v_and_b32 v217, s54, v130
    v_lshlrev_b32 v218, 16, v131
    v_and_b32 v219, s54, v131
    v_add_f32 v188, v188, v204
    v_add_f32 v189, v189, v205
    v_add_f32 v190, v190, v206
    v_add_f32 v191, v191, v207
    v_add_f32 v192, v192, v208
    v_add_f32 v193, v193, v209
    v_add_f32 v194, v194, v210
    v_add_f32 v195, v195, v211
    v_add_f32 v196, v196, v212
    v_add_f32 v197, v197, v213
    v_add_f32 v198, v198, v214
    v_add_f32 v199, v199, v215
    v_add_f32 v200, v200, v216
    v_add_f32 v201, v201, v217
    v_add_f32 v202, v202, v218
    v_add_f32 v203, v203, v219
    s_waitcnt lgkmcnt(2)
    v_lshlrev_b32 v204, 16, v132
    v_and_b32 v205, s54, v132
    v_lshlrev_b32 v206, 16, v133
    v_and_b32 v207, s54, v133
    v_lshlrev_b32 v208, 16, v134
    v_and_b32 v209, s54, v134
    v_lshlrev_b32 v210, 16, v135
    v_and_b32 v211, s54, v135
    v_lshlrev_b32 v212, 16, v136
    v_and_b32 v213, s54, v136
    v_lshlrev_b32 v214, 16, v137
    v_and_b32 v215, s54, v137
    v_lshlrev_b32 v216, 16, v138
    v_and_b32 v217, s54, v138
    v_lshlrev_b32 v218, 16, v139
    v_and_b32 v219, s54, v139
    v_add_f32 v188, v188, v204
    v_add_f32 v189, v189, v205
    v_add_f32 v190, v190, v206
    v_add_f32 v191, v191, v207
    v_add_f32 v192, v192, v208
    v_add_f32 v193, v193, v209
    v_add_f32 v194, v194, v210
    v_add_f32 v195, v195, v211
    v_add_f32 v196, v196, v212
    v_add_f32 v197, v197, v213
    v_add_f32 v198, v198, v214
    v_add_f32 v199, v199, v215
    v_add_f32 v200, v200, v216
    v_add_f32 v201, v201, v217
    v_add_f32 v202, v202, v218
    v_add_f32 v203, v203, v219
    s_waitcnt lgkmcnt(0)
    v_lshlrev_b32 v204, 16, v140
    v_and_b32 v205, s54, v140
    v_lshlrev_b32 v206, 16, v141
    v_and_b32 v207, s54, v141
    v_lshlrev_b32 v208, 16, v142
    v_and_b32 v209, s54, v142
    v_lshlrev_b32 v210, 16, v143
    v_and_b32 v211, s54, v143
    v_lshlrev_b32 v212, 16, v144
    v_and_b32 v213, s54, v144
    v_lshlrev_b32 v214, 16, v145
    v_and_b32 v215, s54, v145
    v_lshlrev_b32 v216, 16, v146
    v_and_b32 v217, s54, v146
    v_lshlrev_b32 v218, 16, v147
    v_and_b32 v219, s54, v147
    v_add_f32 v188, v188, v204
    v_add_f32 v189, v189, v205
    v_add_f32 v190, v190, v206
    v_add_f32 v191, v191, v207
    v_add_f32 v192, v192, v208
    v_add_f32 v193, v193, v209
    v_add_f32 v194, v194, v210
    v_add_f32 v195, v195, v211
    v_add_f32 v196, v196, v212
    v_add_f32 v197, v197, v213
    v_add_f32 v198, v198, v214
    v_add_f32 v199, v199, v215
    v_add_f32 v200, v200, v216
    v_add_f32 v201, v201, v217
    v_add_f32 v202, v202, v218
    v_add_f32 v203, v203, v219
    ds_write_b128 v160, v[188:191]
    ds_write_b128 v161, v[192:195]
    ds_write_b128 v162, v[196:199]
    ds_write_b128 v163, v[200:203]
    v_lshlrev_b32 v168, 16, v184
    v_and_b32 v169, s54, v184
    v_lshlrev_b32 v170, 16, v185
    v_and_b32 v171, s54, v185
    v_lshlrev_b32 v172, 16, v186
    v_and_b32 v173, s54, v186
    v_lshlrev_b32 v174, 16, v187
    v_and_b32 v175, s54, v187
    s_branch K2_FIN8
    ds_write_b128 v5, v[188:191] offset:0
    ds_write_b128 v5, v[192:195] offset:1024
    ds_write_b128 v5, v[196:199] offset:2048
    ds_write_b128 v5, v[200:203] offset:3072
    s_waitcnt lgkmcnt(0)
    s_barrier
    s_endpgm
K1_CONS:
    s_bfe_u32 s3, s2, 0x20003
    s_xor_b32 s3, s3, 1
    s_xor_b32 s3, s3, s40
    s_or_b32 s3, s3, s44
    s_cmp_eq_u32 s3, 0
    s_cbranch_scc0 K1_nozero
    v_mov_b32 v4, 0
    v_mov_b32 v5, 0
    v_mov_b32 v6, 0
    v_mov_b32 v7, 0
    v_lshlrev_b32 v3, 4, v1
    s_mul_i32 s3, s43, 3072
    s_add_u32 s3, s3, 8388608
    s_lshl_b32 s35, s43, 11
    s_add_u32 s35, s35, 8454144
    v_lshlrev_b32 v2, 7, v1
    s_mov_b64 exec, 0xffff
    buffer_store_dword v4, v2, s[20:23], s35 offen sc0 sc1
    s_mov_b64 exec, -1
    buffer_store_dwordx4 v[4:7], v3, s[20:23], s3 offen offset:0 sc0 sc1
    buffer_store_dwordx4 v[4:7], v3, s[20:23], s3 offen offset:1024 sc0 sc1
    buffer_store_dwordx4 v[4:7], v3, s[20:23], s3 offen offset:2048 sc0 sc1
    v_mov_b32 v2, 1
    s_waitcnt vmcnt(0)
    s_mov_b64 exec, 1
    buffer_atomic_add v2, off, s[24:27], 0 sc1
    s_mov_b64 exec, -1
K1_nozero:
    v_and_b32 v3, 31, v1
    v_lshrrev_b32 v4, 5, v1
    v_bfe_u32 v5, v3, 4, 1
    v_xor_b32 v5, v5, v4
    s_lshl_b32 s3, s41, 13
    s_cmp_eq_u32 s58, 2
    s_cselect_b32 s3, 0, s3
    v_bfe_u32 v5, v3, 1, 3
    v_xor_b32 v5, v5, v4
    v_lshl_add_u32 v6, v3, 7, s3
    v_lshl_add_u32 v22, v5, 4, v6
    v_xor_b32 v23, 32, v22
    v_xor_b32 v24, 64, v22
    v_xor_b32 v25, 96, v22
    s_cmp_eq_u32 s58, 2
    s_movk_i32 s3, 18560
    s_cselect_b32 s3, 128, s3
    s_cselect_b32 s66, 5, 7
    s_cselect_b32 s67, s52, s42
    v_bfe_u32 v3, v1, 4, 1
    v_mul_u32_u24 v3, s3, v3
    v_bfe_u32 v5, v1, 2, 2
    v_lshl_add_u32 v5, v4, 3, v5
    v_mul_u32_u24 v5, 288, v5
    v_and_b32 v6, 3, v1
    v_lshlrev_b32 v6, 3, v6
    s_lshl_b32 s3, s67, s66
    s_add_u32 s3, s3, 32768
    v_add3_u32 v26, v3, v5, v6
    v_add_u32 v26, s3, v26
    v_mov_b64 v[28:29], 0
    v_mov_b64 v[30:31], 0
    s_mov_b32 s56, 0
    v_mov_b32 v27, 144000
    ds_write_b128 v27, v[28:31]
    ds_write_b128 v27, v[28:31] offset:16
    ds_write_b128 v27, v[28:31] offset:32
    s_lshl_b32 s3, s43, 2
    s_lshl1_add_u32 s3, s41, s3
    s_mul_i32 s64, s3, 118
    s_add_u32 s64, s64, s46
    s_add_u32 s66, s3, s42
    s_mul_i32 s66, s66, 118
    s_add_u32 s66, s66, s46
    s_add_u32 s66, s66, 8
    s_lshl_b32 s66, s66, 10
    s_lshl2_add_u32 s64, s42, s64
    s_lshl_b32 s64, s64, 10
    s_add_u32 s65, s64, 120832
    s_barrier
    s_cmp_eq_u32 s78, 0
    s_cbranch_scc1 K1_w0
K1_w0done:
    v_mfma_f32_32x32x16_bf16 v[96:111], v[28:31], v[28:31], 0
    v_mfma_f32_32x32x16_bf16 v[112:127], v[28:31], v[28:31], 0
    v_mfma_f32_32x32x16_bf16 v[128:143], v[28:31], v[28:31], 0
    v_mfma_f32_32x32x16_bf16 v[144:159], v[28:31], v[28:31], 0
    v_mfma_f32_32x32x16_bf16 v[160:175], v[28:31], v[28:31], 0
    v_mfma_f32_32x32x16_bf16 v[176:191], v[28:31], v[28:31], 0
    v_mfma_f32_32x32x16_bf16 v[192:207], v[28:31], v[28:31], 0
    v_mfma_f32_32x32x16_bf16 v[208:223], v[28:31], v[28:31], 0
    v_mfma_f32_32x32x16_bf16 v[224:239], v[28:31], v[28:31], 0
    s_barrier
    s_add_u32 m0, s48, 0
    s_add_u32 s50, s49, s51
    buffer_load_dwordx4 v10, s[8:11], s50 offen  lds
    s_add_u32 m0, s48, 1024
    s_nop 0
    buffer_load_dwordx4 v11, s[8:11], s50 offen  lds
    s_add_u32 m0, s48, 2048
    s_nop 0
    buffer_load_dwordx4 v12, s[8:11], s50 offen  lds
    s_add_u32 m0, s48, 3072
    s_nop 0
    buffer_load_dwordx4 v13, s[8:11], s50 offen  lds
    s_add_u32 m0, s48, 4096
    s_nop 0
    buffer_load_dwordx4 v14, s[8:11], s50 offen  lds
K1_w1done:
    s_waitcnt vmcnt(5)
    s_barrier
    s_setprio 1
K1_sel:
    s_cmp_eq_u32 s58, 2
    s_cbranch_scc1 K1_S8
    s_cmp_eq_u32 s58, 1
    s_cbranch_scc0 K1_N8
    s_cmp_eq_u32 s42, 1
    s_cbranch_scc1 K1_N9b
K1_N9a:
    ds_read_b128 v[32:35], v22 offset:0
    ds_read_b64_tr_b16 v[40:41], v26 offset:0
    ds_read_b64_tr_b16 v[42:43], v26 offset:1152
    ds_read_b128 v[36:39], v22 offset:4096
    ds_read_b64_tr_b16 v[44:45], v26 offset:32
    ds_read_b64_tr_b16 v[46:47], v26 offset:1184
    ds_read_b64_tr_b16 v[48:49], v26 offset:64
    ds_read_b64_tr_b16 v[50:51], v26 offset:1216
    ds_read_b64_tr_b16 v[52:53], v26 offset:96
    ds_read_b64_tr_b16 v[54:55], v26 offset:1248
    ds_read_b64_tr_b16 v[56:57], v26 offset:256
    ds_read_b64_tr_b16 v[58:59], v26 offset:1408
K1_N9a_loop:
    s_waitcnt lgkmcnt(9)
    v_mfma_f32_32x32x16_bf16 v[96:111], v[40:43], v[32:35], v[96:111]
    ds_read_b128 v[60:63], v23 offset:0
    ds_read_b64_tr_b16 v[68:69], v26 offset:4608
    s_waitcnt lgkmcnt(10)
    v_mfma_f32_32x32x16_bf16 v[112:127], v[40:43], v[36:39], v[112:127]
    ds_read_b64_tr_b16 v[70:71], v26 offset:5760
    ds_read_b128 v[64:67], v23 offset:4096
    s_waitcnt lgkmcnt(10)
    v_mfma_f32_32x32x16_bf16 v[144:159], v[44:47], v[36:39], v[144:159]
    ds_read_b64_tr_b16 v[72:73], v26 offset:4640
    ds_read_b64_tr_b16 v[74:75], v26 offset:5792
    v_mfma_f32_32x32x16_bf16 v[128:143], v[44:47], v[32:35], v[128:143]
    ds_read_b64_tr_b16 v[76:77], v26 offset:4672
    ds_read_b64_tr_b16 v[78:79], v26 offset:5824
    s_waitcnt lgkmcnt(12)
    v_mfma_f32_32x32x16_bf16 v[160:175], v[48:51], v[32:35], v[160:175]
    ds_read_b64_tr_b16 v[80:81], v26 offset:4704
    ds_read_b64_tr_b16 v[82:83], v26 offset:5856
    v_mfma_f32_32x32x16_bf16 v[176:191], v[48:51], v[36:39], v[176:191]
    ds_read_b64_tr_b16 v[84:85], v26 offset:4864
    ds_read_b64_tr_b16 v[86:87], v26 offset:6016
    s_waitcnt lgkmcnt(14)
    v_mfma_f32_32x32x16_bf16 v[208:223], v[52:55], v[36:39], v[208:223]
    v_mfma_f32_32x32x16_bf16 v[192:207], v[52:55], v[32:35], v[192:207]
    s_waitcnt lgkmcnt(12)
    v_mfma_f32_32x32x16_bf16 v[224:239], v[56:59], v[32:35], v[224:239]
    s_waitcnt lgkmcnt(9)
    v_mfma_f32_32x32x16_bf16 v[96:111], v[68:71], v[60:63], v[96:111]
    ds_read_b128 v[32:35], v24 offset:0
    ds_read_b64_tr_b16 v[40:41], v26 offset:9216
    s_waitcnt lgkmcnt(10)
    v_mfma_f32_32x32x16_bf16 v[112:127], v[68:71], v[64:67], v[112:127]
    ds_read_b64_tr_b16 v[42:43], v26 offset:10368
    ds_read_b128 v[36:39], v24 offset:4096
    s_waitcnt lgkmcnt(10)
    v_mfma_f32_32x32x16_bf16 v[144:159], v[72:75], v[64:67], v[144:159]
    ds_read_b64_tr_b16 v[44:45], v26 offset:9248
    ds_read_b64_tr_b16 v[46:47], v26 offset:10400
    v_mfma_f32_32x32x16_bf16 v[128:143], v[72:75], v[60:63], v[128:143]
    ds_read_b64_tr_b16 v[48:49], v26 offset:9280
    ds_read_b64_tr_b16 v[50:51], v26 offset:10432
    s_waitcnt lgkmcnt(12)
    v_mfma_f32_32x32x16_bf16 v[160:175], v[76:79], v[60:63], v[160:175]
    ds_read_b64_tr_b16 v[52:53], v26 offset:9312
    ds_read_b64_tr_b16 v[54:55], v26 offset:10464
    v_mfma_f32_32x32x16_bf16 v[176:191], v[76:79], v[64:67], v[176:191]
    ds_read_b64_tr_b16 v[56:57], v26 offset:9472
    ds_read_b64_tr_b16 v[58:59], v26 offset:10624
    s_waitcnt lgkmcnt(14)
    v_mfma_f32_32x32x16_bf16 v[208:223], v[80:83], v[64:67], v[208:223]
    s_add_u32 s56, s56, 1
    s_cmp_eq_u32 s56, 3
    s_cselect_b32 s61, 4294893312, s62
    s_cselect_b32 s56, 0, s56
    v_mfma_f32_32x32x16_bf16 v[192:207], v[80:83], v[60:63], v[192:207]
    s_waitcnt lgkmcnt(12)
    v_mfma_f32_32x32x16_bf16 v[224:239], v[84:87], v[60:63], v[224:239]
    s_waitcnt lgkmcnt(9)
    v_mfma_f32_32x32x16_bf16 v[96:111], v[40:43], v[32:35], v[96:111]
    ds_read_b128 v[60:63], v25 offset:0
    ds_read_b64_tr_b16 v[68:69], v26 offset:13824
    s_waitcnt lgkmcnt(10)
    v_mfma_f32_32x32x16_bf16 v[112:127], v[40:43], v[36:39], v[112:127]
    ds_read_b64_tr_b16 v[70:71], v26 offset:14976
    ds_read_b128 v[64:67], v25 offset:4096
    s_waitcnt lgkmcnt(10)
    v_mfma_f32_32x32x16_bf16 v[144:159], v[44:47], v[36:39], v[144:159]
    ds_read_b64_tr_b16 v[72:73], v26 offset:13856
    ds_read_b64_tr_b16 v[74:75], v26 offset:15008
    v_mfma_f32_32x32x16_bf16 v[128:143], v[44:47], v[32:35], v[128:143]
    ds_read_b64_tr_b16 v[76:77], v26 offset:13888
    ds_read_b64_tr_b16 v[78:79], v26 offset:15040
    s_waitcnt lgkmcnt(12)
    v_mfma_f32_32x32x16_bf16 v[160:175], v[48:51], v[32:35], v[160:175]
    ds_read_b64_tr_b16 v[80:81], v26 offset:13920
    ds_read_b64_tr_b16 v[82:83], v26 offset:15072
    v_mfma_f32_32x32x16_bf16 v[176:191], v[48:51], v[36:39], v[176:191]
    ds_read_b64_tr_b16 v[84:85], v26 offset:14080
    ds_read_b64_tr_b16 v[86:87], v26 offset:15232
    s_waitcnt lgkmcnt(14)
    v_mfma_f32_32x32x16_bf16 v[208:223], v[52:55], v[36:39], v[208:223]
    v_xor_b32 v23, 16384, v23
    v_xor_b32 v24, 16384, v24
    v_xor_b32 v25, 16384, v25
    v_mfma_f32_32x32x16_bf16 v[192:207], v[52:55], v[32:35], v[192:207]
    v_xor_b32 v22, 16384, v22
    v_add_u32 v26, s61, v26
    s_add_u32 s47, s47, 1
    s_cmp_lt_u32 s47, 8
    s_waitcnt lgkmcnt(12)
    v_mfma_f32_32x32x16_bf16 v[224:239], v[56:59], v[32:35], v[224:239]
    s_waitcnt lgkmcnt(9)
    v_mfma_f32_32x32x16_bf16 v[96:111], v[68:71], v[60:63], v[96:111]
    s_waitcnt lgkmcnt(8)
    v_mfma_f32_32x32x16_bf16 v[112:127], v[68:71], v[64:67], v[112:127]
    s_waitcnt vmcnt(0) lgkmcnt(0)
    s_barrier
    v_mfma_f32_32x32x16_bf16 v[144:159], v[72:75], v[64:67], v[144:159]
    ds_read_b128 v[32:35], v22 offset:0
    ds_read_b64_tr_b16 v[40:41], v26 offset:0
    ds_read_b64_tr_b16 v[42:43], v26 offset:1152
    v_mfma_f32_32x32x16_bf16 v[128:143], v[72:75], v[60:63], v[128:143]
    ds_read_b128 v[36:39], v22 offset:4096
    ds_read_b64_tr_b16 v[44:45], v26 offset:32
    ds_read_b64_tr_b16 v[46:47], v26 offset:1184
    v_mfma_f32_32x32x16_bf16 v[160:175], v[76:79], v[60:63], v[160:175]
    ds_read_b64_tr_b16 v[48:49], v26 offset:64
    ds_read_b64_tr_b16 v[50:51], v26 offset:1216
    v_mfma_f32_32x32x16_bf16 v[176:191], v[76:79], v[64:67], v[176:191]
    ds_read_b64_tr_b16 v[52:53], v26 offset:96
    ds_read_b64_tr_b16 v[54:55], v26 offset:1248
    v_mfma_f32_32x32x16_bf16 v[208:223], v[80:83], v[64:67], v[208:223]
    ds_read_b64_tr_b16 v[56:57], v26 offset:256
    ds_read_b64_tr_b16 v[58:59], v26 offset:1408
    v_mfma_f32_32x32x16_bf16 v[192:207], v[80:83], v[60:63], v[192:207]
    v_mfma_f32_32x32x16_bf16 v[224:239], v[84:87], v[60:63], v[224:239]
    s_cbranch_scc1 K1_N9a_loop
    s_branch K1_EPI
K1_N9b:
    ds_read_b128 v[32:35], v22 offset:0
    ds_read_b64_tr_b16 v[40:41], v26 offset:0
    ds_read_b64_tr_b16 v[42:43], v26 offset:1152
    ds_read_b128 v[36:39], v22 offset:4096
    ds_read_b64_tr_b16 v[44:45], v26 offset:32
    ds_read_b64_tr_b16 v[46:47], v26 offset:1184
    ds_read_b64_tr_b16 v[48:49], v26 offset:64
    ds_read_b64_tr_b16 v[50:51], v26 offset:1216
    ds_read_b64_tr_b16 v[52:53], v26 offset:96
    ds_read_b64_tr_b16 v[54:55], v26 offset:1248
    ds_read_b64_tr_b16 v[56:57], v26 offset:128
    ds_read_b64_tr_b16 v[58:59], v26 offset:1280
K1_N9b_loop:
    s_waitcnt lgkmcnt(9)
    v_mfma_f32_32x32x16_bf16 v[96:111], v[40:43], v[32:35], v[96:111]
    ds_read_b128 v[60:63], v23 offset:0
    ds_read_b64_tr_b16 v[68:69], v26 offset:4608
    s_waitcnt lgkmcnt(10)
    v_mfma_f32_32x32x16_bf16 v[112:127], v[40:43], v[36:39], v[112:127]
    ds_read_b64_tr_b16 v[70:71], v26 offset:5760
    ds_read_b128 v[64:67], v23 offset:4096
    s_waitcnt lgkmcnt(10)
    v_mfma_f32_32x32x16_bf16 v[144:159], v[44:47], v[36:39], v[144:159]
    ds_read_b64_tr_b16 v[72:73], v26 offset:4640
    ds_read_b64_tr_b16 v[74:75], v26 offset:5792
    v_mfma_f32_32x32x16_bf16 v[128:143], v[44:47], v[32:35], v[128:143]
    ds_read_b64_tr_b16 v[76:77], v26 offset:4672
    ds_read_b64_tr_b16 v[78:79], v26 offset:5824
    s_waitcnt lgkmcnt(12)
    v_mfma_f32_32x32x16_bf16 v[160:175], v[48:51], v[32:35], v[160:175]
    ds_read_b64_tr_b16 v[80:81], v26 offset:4704
    ds_read_b64_tr_b16 v[82:83], v26 offset:5856
    v_mfma_f32_32x32x16_bf16 v[176:191], v[48:51], v[36:39], v[176:191]
    ds_read_b64_tr_b16 v[84:85], v26 offset:4736
    ds_read_b64_tr_b16 v[86:87], v26 offset:5888
    s_waitcnt lgkmcnt(14)
    v_mfma_f32_32x32x16_bf16 v[208:223], v[52:55], v[36:39], v[208:223]
    v_mfma_f32_32x32x16_bf16 v[192:207], v[52:55], v[32:35], v[192:207]
    s_waitcnt lgkmcnt(12)
    v_mfma_f32_32x32x16_bf16 v[224:239], v[56:59], v[36:39], v[224:239]
    s_waitcnt lgkmcnt(9)
    v_mfma_f32_32x32x16_bf16 v[96:111], v[68:71], v[60:63], v[96:111]
    ds_read_b128 v[32:35], v24 offset:0
    ds_read_b64_tr_b16 v[40:41], v26 offset:9216
    s_waitcnt lgkmcnt(10)
    v_mfma_f32_32x32x16_bf16 v[112:127], v[68:71], v[64:67], v[112:127]
    ds_read_b64_tr_b16 v[42:43], v26 offset:10368
    ds_read_b128 v[36:39], v24 offset:4096
    s_waitcnt lgkmcnt(10)
    v_mfma_f32_32x32x16_bf16 v[144:159], v[72:75], v[64:67], v[144:159]
    ds_read_b64_tr_b16 v[44:45], v26 offset:9248
    ds_read_b64_tr_b16 v[46:47], v26 offset:10400
    v_mfma_f32_32x32x16_bf16 v[128:143], v[72:75], v[60:63], v[128:143]
    ds_read_b64_tr_b16 v[48:49], v26 offset:9280
    ds_read_b64_tr_b16 v[50:51], v26 offset:10432
    s_waitcnt lgkmcnt(12)
    v_mfma_f32_32x32x16_bf16 v[160:175], v[76:79], v[60:63], v[160:175]
    ds_read_b64_tr_b16 v[52:53], v26 offset:9312
    ds_read_b64_tr_b16 v[54:55], v26 offset:10464
    v_mfma_f32_32x32x16_bf16 v[176:191], v[76:79], v[64:67], v[176:191]
    ds_read_b64_tr_b16 v[56:57], v26 offset:9344
    ds_read_b64_tr_b16 v[58:59], v26 offset:10496
    s_waitcnt lgkmcnt(14)
    v_mfma_f32_32x32x16_bf16 v[208:223], v[80:83], v[64:67], v[208:223]
    s_add_u32 s56, s56, 1
    s_cmp_eq_u32 s56, 3
    s_cselect_b32 s61, 4294893312, s62
    s_cselect_b32 s56, 0, s56
    v_mfma_f32_32x32x16_bf16 v[192:207], v[80:83], v[60:63], v[192:207]
    s_waitcnt lgkmcnt(12)
    v_mfma_f32_32x32x16_bf16 v[224:239], v[84:87], v[64:67], v[224:239]
    s_waitcnt lgkmcnt(9)
    v_mfma_f32_32x32x16_bf16 v[96:111], v[40:43], v[32:35], v[96:111]
    ds_read_b128 v[60:63], v25 offset:0
    ds_read_b64_tr_b16 v[68:69], v26 offset:13824
    s_waitcnt lgkmcnt(10)
    v_mfma_f32_32x32x16_bf16 v[112:127], v[40:43], v[36:39], v[112:127]
    ds_read_b64_tr_b16 v[70:71], v26 offset:14976
    ds_read_b128 v[64:67], v25 offset:4096
    s_waitcnt lgkmcnt(10)
    v_mfma_f32_32x32x16_bf16 v[144:159], v[44:47], v[36:39], v[144:159]
    ds_read_b64_tr_b16 v[72:73], v26 offset:13856
    ds_read_b64_tr_b16 v[74:75], v26 offset:15008
    v_mfma_f32_32x32x16_bf16 v[128:143], v[44:47], v[32:35], v[128:143]
    ds_read_b64_tr_b16 v[76:77], v26 offset:13888
    ds_read_b64_tr_b16 v[78:79], v26 offset:15040
    s_waitcnt lgkmcnt(12)
    v_mfma_f32_32x32x16_bf16 v[160:175], v[48:51], v[32:35], v[160:175]
    ds_read_b64_tr_b16 v[80:81], v26 offset:13920
    ds_read_b64_tr_b16 v[82:83], v26 offset:15072
    v_mfma_f32_32x32x16_bf16 v[176:191], v[48:51], v[36:39], v[176:191]
    ds_read_b64_tr_b16 v[84:85], v26 offset:13952
    ds_read_b64_tr_b16 v[86:87], v26 offset:15104
    s_waitcnt lgkmcnt(14)
    v_mfma_f32_32x32x16_bf16 v[208:223], v[52:55], v[36:39], v[208:223]
    v_xor_b32 v23, 16384, v23
    v_xor_b32 v24, 16384, v24
    v_xor_b32 v25, 16384, v25
    v_mfma_f32_32x32x16_bf16 v[192:207], v[52:55], v[32:35], v[192:207]
    v_xor_b32 v22, 16384, v22
    v_add_u32 v26, s61, v26
    s_add_u32 s47, s47, 1
    s_cmp_lt_u32 s47, 8
    s_waitcnt lgkmcnt(12)
    v_mfma_f32_32x32x16_bf16 v[224:239], v[56:59], v[36:39], v[224:239]
    s_waitcnt lgkmcnt(9)
    v_mfma_f32_32x32x16_bf16 v[96:111], v[68:71], v[60:63], v[96:111]
    s_waitcnt lgkmcnt(8)
    v_mfma_f32_32x32x16_bf16 v[112:127], v[68:71], v[64:67], v[112:127]
    s_waitcnt vmcnt(0) lgkmcnt(0)
    s_barrier
    v_mfma_f32_32x32x16_bf16 v[144:159], v[72:75], v[64:67], v[144:159]
    ds_read_b128 v[32:35], v22 offset:0
    ds_read_b64_tr_b16 v[40:41], v26 offset:0
    ds_read_b64_tr_b16 v[42:43], v26 offset:1152
    v_mfma_f32_32x32x16_bf16 v[128:143], v[72:75], v[60:63], v[128:143]
    ds_read_b128 v[36:39], v22 offset:4096
    ds_read_b64_tr_b16 v[44:45], v26 offset:32
    ds_read_b64_tr_b16 v[46:47], v26 offset:1184
    v_mfma_f32_32x32x16_bf16 v[160:175], v[76:79], v[60:63], v[160:175]
    ds_read_b64_tr_b16 v[48:49], v26 offset:64
    ds_read_b64_tr_b16 v[50:51], v26 offset:1216
    v_mfma_f32_32x32x16_bf16 v[176:191], v[76:79], v[64:67], v[176:191]
    ds_read_b64_tr_b16 v[52:53], v26 offset:96
    ds_read_b64_tr_b16 v[54:55], v26 offset:1248
    v_mfma_f32_32x32x16_bf16 v[208:223], v[80:83], v[64:67], v[208:223]
    ds_read_b64_tr_b16 v[56:57], v26 offset:128
    ds_read_b64_tr_b16 v[58:59], v26 offset:1280
    v_mfma_f32_32x32x16_bf16 v[192:207], v[80:83], v[60:63], v[192:207]
    v_mfma_f32_32x32x16_bf16 v[224:239], v[84:87], v[64:67], v[224:239]
    s_cbranch_scc1 K1_N9b_loop
    s_branch K1_EPI
K1_N8:
    ds_read_b128 v[32:35], v22 offset:0
    ds_read_b64_tr_b16 v[40:41], v26 offset:0
    ds_read_b64_tr_b16 v[42:43], v26 offset:1152
    ds_read_b128 v[36:39], v22 offset:4096
    ds_read_b64_tr_b16 v[44:45], v26 offset:32
    ds_read_b64_tr_b16 v[46:47], v26 offset:1184
    ds_read_b64_tr_b16 v[48:49], v26 offset:64
    ds_read_b64_tr_b16 v[50:51], v26 offset:1216
    ds_read_b64_tr_b16 v[52:53], v26 offset:96
    ds_read_b64_tr_b16 v[54:55], v26 offset:1248
K1_N8_loop:
    s_waitcnt lgkmcnt(7)
    v_mfma_f32_32x32x16_bf16 v[96:111], v[40:43], v[32:35], v[96:111]
    ds_read_b128 v[60:63], v23 offset:0
    ds_read_b64_tr_b16 v[68:69], v26 offset:4608
    s_waitcnt lgkmcnt(8)
    v_mfma_f32_32x32x16_bf16 v[112:127], v[40:43], v[36:39], v[112:127]
    ds_read_b64_tr_b16 v[70:71], v26 offset:5760
    ds_read_b128 v[64:67], v23 offset:4096
    s_waitcnt lgkmcnt(8)
    v_mfma_f32_32x32x16_bf16 v[144:159], v[44:47], v[36:39], v[144:159]
    ds_read_b64_tr_b16 v[72:73], v26 offset:4640
    ds_read_b64_tr_b16 v[74:75], v26 offset:5792
    v_mfma_f32_32x32x16_bf16 v[128:143], v[44:47], v[32:35], v[128:143]
    ds_read_b64_tr_b16 v[76:77], v26 offset:4672
    ds_read_b64_tr_b16 v[78:79], v26 offset:5824
    s_waitcnt lgkmcnt(10)
    v_mfma_f32_32x32x16_bf16 v[160:175], v[48:51], v[32:35], v[160:175]
    ds_read_b64_tr_b16 v[80:81], v26 offset:4704
    ds_read_b64_tr_b16 v[82:83], v26 offset:5856
    v_mfma_f32_32x32x16_bf16 v[176:191], v[48:51], v[36:39], v[176:191]
    s_waitcnt lgkmcnt(10)
    v_mfma_f32_32x32x16_bf16 v[208:223], v[52:55], v[36:39], v[208:223]
    v_mfma_f32_32x32x16_bf16 v[192:207], v[52:55], v[32:35], v[192:207]
    s_waitcnt lgkmcnt(7)
    v_mfma_f32_32x32x16_bf16 v[96:111], v[68:71], v[60:63], v[96:111]
    ds_read_b128 v[32:35], v24 offset:0
    ds_read_b64_tr_b16 v[40:41], v26 offset:9216
    s_waitcnt lgkmcnt(8)
    v_mfma_f32_32x32x16_bf16 v[112:127], v[68:71], v[64:67], v[112:127]
    ds_read_b64_tr_b16 v[42:43], v26 offset:10368
    ds_read_b128 v[36:39], v24 offset:4096
    s_waitcnt lgkmcnt(8)
    v_mfma_f32_32x32x16_bf16 v[144:159], v[72:75], v[64:67], v[144:159]
    ds_read_b64_tr_b16 v[44:45], v26 offset:9248
    ds_read_b64_tr_b16 v[46:47], v26 offset:10400
    v_mfma_f32_32x32x16_bf16 v[128:143], v[72:75], v[60:63], v[128:143]
    ds_read_b64_tr_b16 v[48:49], v26 offset:9280
    ds_read_b64_tr_b16 v[50:51], v26 offset:10432
    s_waitcnt lgkmcnt(10)
    v_mfma_f32_32x32x16_bf16 v[160:175], v[76:79], v[60:63], v[160:175]
    ds_read_b64_tr_b16 v[52:53], v26 offset:9312
    ds_read_b64_tr_b16 v[54:55], v26 offset:10464
    v_mfma_f32_32x32x16_bf16 v[176:191], v[76:79], v[64:67], v[176:191]
    s_waitcnt lgkmcnt(10)
    v_mfma_f32_32x32x16_bf16 v[208:223], v[80:83], v[64:67], v[208:223]
    s_add_u32 s56, s56, 1
    s_cmp_eq_u32 s56, 3
    s_cselect_b32 s61, 4294893312, s62
    s_cselect_b32 s56, 0, s56
    v_mfma_f32_32x32x16_bf16 v[192:207], v[80:83], v[60:63], v[192:207]
    s_waitcnt lgkmcnt(7)
    v_mfma_f32_32x32x16_bf16 v[96:111], v[40:43], v[32:35], v[96:111]
    ds_read_b128 v[60:63], v25 offset:0
    ds_read_b64_tr_b16 v[68:69], v26 offset:13824
    s_waitcnt lgkmcnt(8)
    v_mfma_f32_32x32x16_bf16 v[112:127], v[40:43], v[36:39], v[112:127]
    ds_read_b64_tr_b16 v[70:71], v26 offset:14976
    ds_read_b128 v[64:67], v25 offset:4096
    s_waitcnt lgkmcnt(8)
    v_mfma_f32_32x32x16_bf16 v[144:159], v[44:47], v[36:39], v[144:159]
    ds_read_b64_tr_b16 v[72:73], v26 offset:13856
    ds_read_b64_tr_b16 v[74:75], v26 offset:15008
    v_mfma_f32_32x32x16_bf16 v[128:143], v[44:47], v[32:35], v[128:143]
    ds_read_b64_tr_b16 v[76:77], v26 offset:13888
    ds_read_b64_tr_b16 v[78:79], v26 offset:15040
    s_waitcnt lgkmcnt(10)
    v_mfma_f32_32x32x16_bf16 v[160:175], v[48:51], v[32:35], v[160:175]
    ds_read_b64_tr_b16 v[80:81], v26 offset:13920
    ds_read_b64_tr_b16 v[82:83], v26 offset:15072
    v_mfma_f32_32x32x16_bf16 v[176:191], v[48:51], v[36:39], v[176:191]
    s_waitcnt lgkmcnt(10)
    v_mfma_f32_32x32x16_bf16 v[208:223], v[52:55], v[36:39], v[208:223]
    v_xor_b32 v23, 16384, v23
    v_xor_b32 v24, 16384, v24
    v_xor_b32 v25, 16384, v25
    v_mfma_f32_32x32x16_bf16 v[192:207], v[52:55], v[32:35], v[192:207]
    v_xor_b32 v22, 16384, v22
    v_add_u32 v26, s61, v26
    s_add_u32 s47, s47, 1
    s_cmp_lt_u32 s47, 8
    s_waitcnt lgkmcnt(7)
    v_mfma_f32_32x32x16_bf16 v[96:111], v[68:71], v[60:63], v[96:111]
    s_waitcnt lgkmcnt(6)
    v_mfma_f32_32x32x16_bf16 v[112:127], v[68:71], v[64:67], v[112:127]
    s_waitcnt vmcnt(0) lgkmcnt(0)
    s_barrier
    v_mfma_f32_32x32x16_bf16 v[144:159], v[72:75], v[64:67], v[144:159]
    ds_read_b128 v[32:35], v22 offset:0
    ds_read_b64_tr_b16 v[40:41], v26 offset:0
    ds_read_b64_tr_b16 v[42:43], v26 offset:1152
    v_mfma_f32_32x32x16_bf16 v[128:143], v[72:75], v[60:63], v[128:143]
    ds_read_b128 v[36:39], v22 offset:4096
    ds_read_b64_tr_b16 v[44:45], v26 offset:32
    ds_read_b64_tr_b16 v[46:47], v26 offset:1184
    v_mfma_f32_32x32x16_bf16 v[160:175], v[76:79], v[60:63], v[160:175]
    ds_read_b64_tr_b16 v[48:49], v26 offset:64
    ds_read_b64_tr_b16 v[50:51], v26 offset:1216
    v_mfma_f32_32x32x16_bf16 v[176:191], v[76:79], v[64:67], v[176:191]
    ds_read_b64_tr_b16 v[52:53], v26 offset:96
    ds_read_b64_tr_b16 v[54:55], v26 offset:1248
    v_mfma_f32_32x32x16_bf16 v[208:223], v[80:83], v[64:67], v[208:223]
    v_mfma_f32_32x32x16_bf16 v[192:207], v[80:83], v[60:63], v[192:207]
    s_cbranch_scc1 K1_N8_loop
    s_branch K1_EPI
K1_S8:
    ds_read_b128 v[32:35], v22 offset:0
    ds_read_b64_tr_b16 v[48:49], v26 offset:0
    ds_read_b64_tr_b16 v[50:51], v26 offset:1152
    ds_read_b64_tr_b16 v[52:53], v26 offset:18560
    ds_read_b64_tr_b16 v[54:55], v26 offset:19712
    ds_read_b128 v[36:39], v22 offset:4096
    ds_read_b128 v[40:43], v22 offset:8192
    ds_read_b128 v[44:47], v22 offset:12288
K1_S8_loop:
    s_waitcnt lgkmcnt(5)
    v_mfma_f32_32x32x16_bf16 v[96:111], v[32:35], v[48:51], v[96:111]
    ds_read_b128 v[60:63], v23 offset:0
    ds_read_b64_tr_b16 v[76:77], v26 offset:4608
    s_waitcnt lgkmcnt(5)
    v_mfma_f32_32x32x16_bf16 v[160:175], v[32:35], v[52:55], v[160:175]
    ds_read_b64_tr_b16 v[78:79], v26 offset:5760
    ds_read_b64_tr_b16 v[80:81], v26 offset:23168
    s_waitcnt lgkmcnt(6)
    v_mfma_f32_32x32x16_bf16 v[176:191], v[36:39], v[52:55], v[176:191]
    ds_read_b64_tr_b16 v[82:83], v26 offset:24320
    v_mfma_f32_32x32x16_bf16 v[112:127], v[36:39], v[48:51], v[112:127]
    ds_read_b128 v[64:67], v23 offset:4096
    s_waitcnt lgkmcnt(7)
    v_mfma_f32_32x32x16_bf16 v[128:143], v[40:43], v[48:51], v[128:143]
    ds_read_b128 v[68:71], v23 offset:8192
    v_mfma_f32_32x32x16_bf16 v[192:207], v[40:43], v[52:55], v[192:207]
    ds_read_b128 v[72:75], v23 offset:12288
    s_waitcnt lgkmcnt(8)
    v_mfma_f32_32x32x16_bf16 v[208:223], v[44:47], v[52:55], v[208:223]
    v_mfma_f32_32x32x16_bf16 v[144:159], v[44:47], v[48:51], v[144:159]
    s_waitcnt lgkmcnt(5)
    v_mfma_f32_32x32x16_bf16 v[96:111], v[60:63], v[76:79], v[96:111]
    ds_read_b128 v[32:35], v24 offset:0
    ds_read_b64_tr_b16 v[48:49], v26 offset:9216
    s_waitcnt lgkmcnt(5)
    v_mfma_f32_32x32x16_bf16 v[160:175], v[60:63], v[80:83], v[160:175]
    ds_read_b64_tr_b16 v[50:51], v26 offset:10368
    ds_read_b64_tr_b16 v[52:53], v26 offset:27776
    s_waitcnt lgkmcnt(6)
    v_mfma_f32_32x32x16_bf16 v[176:191], v[64:67], v[80:83], v[176:191]
    ds_read_b64_tr_b16 v[54:55], v26 offset:28928
    v_mfma_f32_32x32x16_bf16 v[112:127], v[64:67], v[76:79], v[112:127]
    ds_read_b128 v[36:39], v24 offset:4096
    s_waitcnt lgkmcnt(7)
    v_mfma_f32_32x32x16_bf16 v[128:143], v[68:71], v[76:79], v[128:143]
    ds_read_b128 v[40:43], v24 offset:8192
    v_mfma_f32_32x32x16_bf16 v[192:207], v[68:71], v[80:83], v[192:207]
    ds_read_b128 v[44:47], v24 offset:12288
    s_waitcnt lgkmcnt(8)
    v_mfma_f32_32x32x16_bf16 v[208:223], v[72:75], v[80:83], v[208:223]
    s_add_u32 s56, s56, 1
    s_cmp_eq_u32 s56, 3
    s_cselect_b32 s61, 4294893312, s62
    s_cselect_b32 s56, 0, s56
    v_mfma_f32_32x32x16_bf16 v[144:159], v[72:75], v[76:79], v[144:159]
    s_waitcnt lgkmcnt(5)
    v_mfma_f32_32x32x16_bf16 v[96:111], v[32:35], v[48:51], v[96:111]
    ds_read_b128 v[60:63], v25 offset:0
    ds_read_b64_tr_b16 v[76:77], v26 offset:13824
    s_waitcnt lgkmcnt(5)
    v_mfma_f32_32x32x16_bf16 v[160:175], v[32:35], v[52:55], v[160:175]
    ds_read_b64_tr_b16 v[78:79], v26 offset:14976
    ds_read_b64_tr_b16 v[80:81], v26 offset:32384
    s_waitcnt lgkmcnt(6)
    v_mfma_f32_32x32x16_bf16 v[176:191], v[36:39], v[52:55], v[176:191]
    ds_read_b64_tr_b16 v[82:83], v26 offset:33536
    v_mfma_f32_32x32x16_bf16 v[112:127], v[36:39], v[48:51], v[112:127]
    ds_read_b128 v[64:67], v25 offset:4096
    s_waitcnt lgkmcnt(7)
    v_mfma_f32_32x32x16_bf16 v[128:143], v[40:43], v[48:51], v[128:143]
    ds_read_b128 v[68:71], v25 offset:8192
    v_mfma_f32_32x32x16_bf16 v[192:207], v[40:43], v[52:55], v[192:207]
    ds_read_b128 v[72:75], v25 offset:12288
    s_waitcnt lgkmcnt(8)
    v_mfma_f32_32x32x16_bf16 v[208:223], v[44:47], v[52:55], v[208:223]
    v_xor_b32 v23, 16384, v23
    v_xor_b32 v24, 16384, v24
    v_xor_b32 v25, 16384, v25
    v_mfma_f32_32x32x16_bf16 v[144:159], v[44:47], v[48:51], v[144:159]
    v_xor_b32 v22, 16384, v22
    v_add_u32 v26, s61, v26
    s_add_u32 s47, s47, 1
    s_cmp_lt_u32 s47, 8
    s_waitcnt lgkmcnt(5)
    v_mfma_f32_32x32x16_bf16 v[96:111], v[60:63], v[76:79], v[96:111]
    s_waitcnt lgkmcnt(3)
    v_mfma_f32_32x32x16_bf16 v[160:175], v[60:63], v[80:83], v[160:175]
    s_waitcnt vmcnt(0) lgkmcnt(0)
    s_barrier
    v_mfma_f32_32x32x16_bf16 v[176:191], v[64:67], v[80:83], v[176:191]
    ds_read_b128 v[32:35], v22 offset:0
    ds_read_b64_tr_b16 v[48:49], v26 offset:0
    ds_read_b64_tr_b16 v[50:51], v26 offset:1152
    v_mfma_f32_32x32x16_bf16 v[112:127], v[64:67], v[76:79], v[112:127]
    ds_read_b64_tr_b16 v[52:53], v26 offset:18560
    ds_read_b64_tr_b16 v[54:55], v26 offset:19712
    ds_read_b128 v[36:39], v22 offset:4096
    v_mfma_f32_32x32x16_bf16 v[128:143], v[68:71], v[76:79], v[128:143]
    ds_read_b128 v[40:43], v22 offset:8192
    ds_read_b128 v[44:47], v22 offset:12288
    v_mfma_f32_32x32x16_bf16 v[192:207], v[68:71], v[80:83], v[192:207]
    v_mfma_f32_32x32x16_bf16 v[208:223], v[72:75], v[80:83], v[208:223]
    v_mfma_f32_32x32x16_bf16 v[144:159], v[72:75], v[76:79], v[144:159]
    s_cbranch_scc1 K1_S8_loop
    s_branch K1_EPI
K1_EPI:
    s_waitcnt lgkmcnt(0)
    v_lshlrev_b32 v10, 4, v1
    s_cmp_eq_u32 s58, 2
    s_cbranch_scc1 K1_EPI_KV
    s_cmp_eq_u32 s58, 3
    s_cbranch_scc1 K1_EPI_Q
    v_mov_b32 v12, 0xbdd2d3e8
    v_mov_b32 v13, 0xc0135761
    v_pk_mul_f32 v[32:33], v[96:97], v[96:97]
    v_pk_mul_f32 v[34:35], v[98:99], v[98:99]
    v_pk_mul_f32 v[36:37], v[100:101], v[100:101]
    v_pk_mul_f32 v[38:39], v[102:103], v[102:103]
    v_pk_mul_f32 v[40:41], v[112:113], v[112:113]
    v_pk_mul_f32 v[42:43], v[114:115], v[114:115]
    v_pk_mul_f32 v[44:45], v[116:117], v[116:117]
    v_pk_mul_f32 v[46:47], v[118:119], v[118:119]
    v_pk_fma_f32 v[32:33], v[32:33], v[12:13], v[12:13] op_sel:[0,0,1] op_sel_hi:[1,0,1]
    v_pk_fma_f32 v[34:35], v[34:35], v[12:13], v[12:13] op_sel:[0,0,1] op_sel_hi:[1,0,1]
    v_pk_fma_f32 v[36:37], v[36:37], v[12:13], v[12:13] op_sel:[0,0,1] op_sel_hi:[1,0,1]
    v_pk_fma_f32 v[38:39], v[38:39], v[12:13], v[12:13] op_sel:[0,0,1] op_sel_hi:[1,0,1]
    v_pk_fma_f32 v[40:41], v[40:41], v[12:13], v[12:13] op_sel:[0,0,1] op_sel_hi:[1,0,1]
    v_pk_fma_f32 v[42:43], v[42:43], v[12:13], v[12:13] op_sel:[0,0,1] op_sel_hi:[1,0,1]
    v_pk_fma_f32 v[44:45], v[44:45], v[12:13], v[12:13] op_sel:[0,0,1] op_sel_hi:[1,0,1]
    v_pk_fma_f32 v[46:47], v[46:47], v[12:13], v[12:13] op_sel:[0,0,1] op_sel_hi:[1,0,1]
    v_pk_mul_f32 v[32:33], v[32:33], v[96:97]
    v_pk_mul_f32 v[34:35], v[34:35], v[98:99]
    v_pk_mul_f32 v[36:37], v[36:37], v[100:101]
    v_pk_mul_f32 v[38:39], v[38:39], v[102:103]
    v_pk_mul_f32 v[40:41], v[40:41], v[112:113]
    v_pk_mul_f32 v[42:43], v[42:43], v[114:115]
    v_pk_mul_f32 v[44:45], v[44:45], v[116:117]
    v_pk_mul_f32 v[46:47], v[46:47], v[118:119]
    v_exp_f32 v32, v32
    v_exp_f32 v33, v33
    v_exp_f32 v34, v34
    v_exp_f32 v35, v35
    v_exp_f32 v36, v36
    v_exp_f32 v37, v37
    v_exp_f32 v38, v38
    v_exp_f32 v39, v39
    v_exp_f32 v40, v40
    v_exp_f32 v41, v41
    v_exp_f32 v42, v42
    v_exp_f32 v43, v43
    v_exp_f32 v44, v44
    v_exp_f32 v45, v45
    v_exp_f32 v46, v46
    v_exp_f32 v47, v47
    v_pk_mul_f32 v[96:97], v[96:97], v[104:105]
    v_pk_mul_f32 v[98:99], v[98:99], v[106:107]
    v_pk_mul_f32 v[100:101], v[100:101], v[108:109]
    v_pk_mul_f32 v[102:103], v[102:103], v[110:111]
    v_pk_mul_f32 v[112:113], v[112:113], v[120:121]
    v_pk_mul_f32 v[114:115], v[114:115], v[122:123]
    v_pk_mul_f32 v[116:117], v[116:117], v[124:125]
    v_pk_mul_f32 v[118:119], v[118:119], v[126:127]
    v_pk_add_f32 v[32:33], v[32:33], 1.0 op_sel_hi:[1,0]
    v_pk_add_f32 v[34:35], v[34:35], 1.0 op_sel_hi:[1,0]
    v_pk_add_f32 v[36:37], v[36:37], 1.0 op_sel_hi:[1,0]
    v_pk_add_f32 v[38:39], v[38:39], 1.0 op_sel_hi:[1,0]
    v_pk_add_f32 v[40:41], v[40:41], 1.0 op_sel_hi:[1,0]
    v_pk_add_f32 v[42:43], v[42:43], 1.0 op_sel_hi:[1,0]
    v_pk_add_f32 v[44:45], v[44:45], 1.0 op_sel_hi:[1,0]
    v_pk_add_f32 v[46:47], v[46:47], 1.0 op_sel_hi:[1,0]
    v_rcp_f32 v32, v32
    v_rcp_f32 v33, v33
    v_rcp_f32 v34, v34
    v_rcp_f32 v35, v35
    v_rcp_f32 v36, v36
    v_rcp_f32 v37, v37
    v_rcp_f32 v38, v38
    v_rcp_f32 v39, v39
    v_rcp_f32 v40, v40
    v_rcp_f32 v41, v41
    v_rcp_f32 v42, v42
    v_rcp_f32 v43, v43
    v_rcp_f32 v44, v44
    v_rcp_f32 v45, v45
    v_rcp_f32 v46, v46
    v_rcp_f32 v47, v47
    v_pk_mul_f32 v[96:97], v[96:97], v[32:33]
    v_pk_mul_f32 v[98:99], v[98:99], v[34:35]
    v_pk_mul_f32 v[100:101], v[100:101], v[36:37]
    v_pk_mul_f32 v[102:103], v[102:103], v[38:39]
    v_pk_mul_f32 v[112:113], v[112:113], v[40:41]
    v_pk_mul_f32 v[114:115], v[114:115], v[42:43]
    v_pk_mul_f32 v[116:117], v[116:117], v[44:45]
    v_pk_mul_f32 v[118:119], v[118:119], v[46:47]
    v_cvt_pk_bf16_f32 v48, v96, v97
    v_cvt_pk_bf16_f32 v49, v98, v99
    v_cvt_pk_bf16_f32 v50, v100, v101
    v_cvt_pk_bf16_f32 v51, v102, v103
    v_cvt_pk_bf16_f32 v52, v112, v113
    v_cvt_pk_bf16_f32 v53, v114, v115
    v_cvt_pk_bf16_f32 v54, v116, v117
    v_cvt_pk_bf16_f32 v55, v118, v119
    buffer_store_dwordx4 v[48:51], v10, s[20:23], s64 offen offset:0 sc0 sc1
    buffer_store_dwordx4 v[52:55], v10, s[20:23], s65 offen offset:0 sc0 sc1
    v_pk_mul_f32 v[56:57], v[128:129], v[128:129]
    v_pk_mul_f32 v[58:59], v[130:131], v[130:131]
    v_pk_mul_f32 v[60:61], v[132:133], v[132:133]
    v_pk_mul_f32 v[62:63], v[134:135], v[134:135]
    v_pk_mul_f32 v[64:65], v[144:145], v[144:145]
    v_pk_mul_f32 v[66:67], v[146:147], v[146:147]
    v_pk_mul_f32 v[68:69], v[148:149], v[148:149]
    v_pk_mul_f32 v[70:71], v[150:151], v[150:151]
    v_pk_fma_f32 v[56:57], v[56:57], v[12:13], v[12:13] op_sel:[0,0,1] op_sel_hi:[1,0,1]
    v_pk_fma_f32 v[58:59], v[58:59], v[12:13], v[12:13] op_sel:[0,0,1] op_sel_hi:[1,0,1]
    v_pk_fma_f32 v[60:61], v[60:61], v[12:13], v[12:13] op_sel:[0,0,1] op_sel_hi:[1,0,1]
    v_pk_fma_f32 v[62:63], v[62:63], v[12:13], v[12:13] op_sel:[0,0,1] op_sel_hi:[1,0,1]
    v_pk_fma_f32 v[64:65], v[64:65], v[12:13], v[12:13] op_sel:[0,0,1] op_sel_hi:[1,0,1]
    v_pk_fma_f32 v[66:67], v[66:67], v[12:13], v[12:13] op_sel:[0,0,1] op_sel_hi:[1,0,1]
    v_pk_fma_f32 v[68:69], v[68:69], v[12:13], v[12:13] op_sel:[0,0,1] op_sel_hi:[1,0,1]
    v_pk_fma_f32 v[70:71], v[70:71], v[12:13], v[12:13] op_sel:[0,0,1] op_sel_hi:[1,0,1]
    v_pk_mul_f32 v[56:57], v[56:57], v[128:129]
    v_pk_mul_f32 v[58:59], v[58:59], v[130:131]
    v_pk_mul_f32 v[60:61], v[60:61], v[132:133]
    v_pk_mul_f32 v[62:63], v[62:63], v[134:135]
    v_pk_mul_f32 v[64:65], v[64:65], v[144:145]
    v_pk_mul_f32 v[66:67], v[66:67], v[146:147]
    v_pk_mul_f32 v[68:69], v[68:69], v[148:149]
    v_pk_mul_f32 v[70:71], v[70:71], v[150:151]
    v_exp_f32 v56, v56
    v_exp_f32 v57, v57
    v_exp_f32 v58, v58
    v_exp_f32 v59, v59
    v_exp_f32 v60, v60
    v_exp_f32 v61, v61
    v_exp_f32 v62, v62
    v_exp_f32 v63, v63
    v_exp_f32 v64, v64
    v_exp_f32 v65, v65
    v_exp_f32 v66, v66
    v_exp_f32 v67, v67
    v_exp_f32 v68, v68
    v_exp_f32 v69, v69
    v_exp_f32 v70, v70
    v_exp_f32 v71, v71
    v_pk_mul_f32 v[128:129], v[128:129], v[136:137]
    v_pk_mul_f32 v[130:131], v[130:131], v[138:139]
    v_pk_mul_f32 v[132:133], v[132:133], v[140:141]
    v_pk_mul_f32 v[134:135], v[134:135], v[142:143]
    v_pk_mul_f32 v[144:145], v[144:145], v[152:153]
    v_pk_mul_f32 v[146:147], v[146:147], v[154:155]
    v_pk_mul_f32 v[148:149], v[148:149], v[156:157]
    v_pk_mul_f32 v[150:151], v[150:151], v[158:159]
    v_pk_add_f32 v[56:57], v[56:57], 1.0 op_sel_hi:[1,0]
    v_pk_add_f32 v[58:59], v[58:59], 1.0 op_sel_hi:[1,0]
    v_pk_add_f32 v[60:61], v[60:61], 1.0 op_sel_hi:[1,0]
    v_pk_add_f32 v[62:63], v[62:63], 1.0 op_sel_hi:[1,0]
    v_pk_add_f32 v[64:65], v[64:65], 1.0 op_sel_hi:[1,0]
    v_pk_add_f32 v[66:67], v[66:67], 1.0 op_sel_hi:[1,0]
    v_pk_add_f32 v[68:69], v[68:69], 1.0 op_sel_hi:[1,0]
    v_pk_add_f32 v[70:71], v[70:71], 1.0 op_sel_hi:[1,0]
    v_rcp_f32 v56, v56
    v_rcp_f32 v57, v57
    v_rcp_f32 v58, v58
    v_rcp_f32 v59, v59
    v_rcp_f32 v60, v60
    v_rcp_f32 v61, v61
    v_rcp_f32 v62, v62
    v_rcp_f32 v63, v63
    v_rcp_f32 v64, v64
    v_rcp_f32 v65, v65
    v_rcp_f32 v66, v66
    v_rcp_f32 v67, v67
    v_rcp_f32 v68, v68
    v_rcp_f32 v69, v69
    v_rcp_f32 v70, v70
    v_rcp_f32 v71, v71
    v_pk_mul_f32 v[128:129], v[128:129], v[56:57]
    v_pk_mul_f32 v[130:131], v[130:131], v[58:59]
    v_pk_mul_f32 v[132:133], v[132:133], v[60:61]
    v_pk_mul_f32 v[134:135], v[134:135], v[62:63]
    v_pk_mul_f32 v[144:145], v[144:145], v[64:65]
    v_pk_mul_f32 v[146:147], v[146:147], v[66:67]
    v_pk_mul_f32 v[148:149], v[148:149], v[68:69]
    v_pk_mul_f32 v[150:151], v[150:151], v[70:71]
    v_cvt_pk_bf16_f32 v72, v128, v129
    v_cvt_pk_bf16_f32 v73, v130, v131
    v_cvt_pk_bf16_f32 v74, v132, v133
    v_cvt_pk_bf16_f32 v75, v134, v135
    v_cvt_pk_bf16_f32 v76, v144, v145
    v_cvt_pk_bf16_f32 v77, v146, v147
    v_cvt_pk_bf16_f32 v78, v148, v149
    v_cvt_pk_bf16_f32 v79, v150, v151
    buffer_store_dwordx4 v[72:75], v10, s[20:23], s64 offen offset:1024 sc0 sc1
    buffer_store_dwordx4 v[76:79], v10, s[20:23], s65 offen offset:1024 sc0 sc1
    v_pk_mul_f32 v[32:33], v[160:161], v[160:161]
    v_pk_mul_f32 v[34:35], v[162:163], v[162:163]
    v_pk_mul_f32 v[36:37], v[164:165], v[164:165]
    v_pk_mul_f32 v[38:39], v[166:167], v[166:167]
    v_pk_mul_f32 v[40:41], v[176:177], v[176:177]
    v_pk_mul_f32 v[42:43], v[178:179], v[178:179]
    v_pk_mul_f32 v[44:45], v[180:181], v[180:181]
    v_pk_mul_f32 v[46:47], v[182:183], v[182:183]
    v_pk_fma_f32 v[32:33], v[32:33], v[12:13], v[12:13] op_sel:[0,0,1] op_sel_hi:[1,0,1]
    v_pk_fma_f32 v[34:35], v[34:35], v[12:13], v[12:13] op_sel:[0,0,1] op_sel_hi:[1,0,1]
    v_pk_fma_f32 v[36:37], v[36:37], v[12:13], v[12:13] op_sel:[0,0,1] op_sel_hi:[1,0,1]
    v_pk_fma_f32 v[38:39], v[38:39], v[12:13], v[12:13] op_sel:[0,0,1] op_sel_hi:[1,0,1]
    v_pk_fma_f32 v[40:41], v[40:41], v[12:13], v[12:13] op_sel:[0,0,1] op_sel_hi:[1,0,1]
    v_pk_fma_f32 v[42:43], v[42:43], v[12:13], v[12:13] op_sel:[0,0,1] op_sel_hi:[1,0,1]
    v_pk_fma_f32 v[44:45], v[44:45], v[12:13], v[12:13] op_sel:[0,0,1] op_sel_hi:[1,0,1]
    v_pk_fma_f32 v[46:47], v[46:47], v[12:13], v[12:13] op_sel:[0,0,1] op_sel_hi:[1,0,1]
    v_pk_mul_f32 v[32:33], v[32:33], v[160:161]
    v_pk_mul_f32 v[34:35], v[34:35], v[162:163]
    v_pk_mul_f32 v[36:37], v[36:37], v[164:165]
    v_pk_mul_f32 v[38:39], v[38:39], v[166:167]
    v_pk_mul_f32 v[40:41], v[40:41], v[176:177]
    v_pk_mul_f32 v[42:43], v[42:43], v[178:179]
    v_pk_mul_f32 v[44:45], v[44:45], v[180:181]
    v_pk_mul_f32 v[46:47], v[46:47], v[182:183]
    v_exp_f32 v32, v32
    v_exp_f32 v33, v33
    v_exp_f32 v34, v34
    v_exp_f32 v35, v35
    v_exp_f32 v36, v36
    v_exp_f32 v37, v37
    v_exp_f32 v38, v38
    v_exp_f32 v39, v39
    v_exp_f32 v40, v40
    v_exp_f32 v41, v41
    v_exp_f32 v42, v42
    v_exp_f32 v43, v43
    v_exp_f32 v44, v44
    v_exp_f32 v45, v45
    v_exp_f32 v46, v46
    v_exp_f32 v47, v47
    v_pk_mul_f32 v[160:161], v[160:161], v[168:169]
    v_pk_mul_f32 v[162:163], v[162:163], v[170:171]
    v_pk_mul_f32 v[164:165], v[164:165], v[172:173]
    v_pk_mul_f32 v[166:167], v[166:167], v[174:175]
    v_pk_mul_f32 v[176:177], v[176:177], v[184:185]
    v_pk_mul_f32 v[178:179], v[178:179], v[186:187]
    v_pk_mul_f32 v[180:181], v[180:181], v[188:189]
    v_pk_mul_f32 v[182:183], v[182:183], v[190:191]
    v_pk_add_f32 v[32:33], v[32:33], 1.0 op_sel_hi:[1,0]
    v_pk_add_f32 v[34:35], v[34:35], 1.0 op_sel_hi:[1,0]
    v_pk_add_f32 v[36:37], v[36:37], 1.0 op_sel_hi:[1,0]
    v_pk_add_f32 v[38:39], v[38:39], 1.0 op_sel_hi:[1,0]
    v_pk_add_f32 v[40:41], v[40:41], 1.0 op_sel_hi:[1,0]
    v_pk_add_f32 v[42:43], v[42:43], 1.0 op_sel_hi:[1,0]
    v_pk_add_f32 v[44:45], v[44:45], 1.0 op_sel_hi:[1,0]
    v_pk_add_f32 v[46:47], v[46:47], 1.0 op_sel_hi:[1,0]
    v_rcp_f32 v32, v32
    v_rcp_f32 v33, v33
    v_rcp_f32 v34, v34
    v_rcp_f32 v35, v35
    v_rcp_f32 v36, v36
    v_rcp_f32 v37, v37
    v_rcp_f32 v38, v38
    v_rcp_f32 v39, v39
    v_rcp_f32 v40, v40
    v_rcp_f32 v41, v41
    v_rcp_f32 v42, v42
    v_rcp_f32 v43, v43
    v_rcp_f32 v44, v44
    v_rcp_f32 v45, v45
    v_rcp_f32 v46, v46
    v_rcp_f32 v47, v47
    v_pk_mul_f32 v[160:161], v[160:161], v[32:33]
    v_pk_mul_f32 v[162:163], v[162:163], v[34:35]
    v_pk_mul_f32 v[164:165], v[164:165], v[36:37]
    v_pk_mul_f32 v[166:167], v[166:167], v[38:39]
    v_pk_mul_f32 v[176:177], v[176:177], v[40:41]
    v_pk_mul_f32 v[178:179], v[178:179], v[42:43]
    v_pk_mul_f32 v[180:181], v[180:181], v[44:45]
    v_pk_mul_f32 v[182:183], v[182:183], v[46:47]
    v_cvt_pk_bf16_f32 v48, v160, v161
    v_cvt_pk_bf16_f32 v49, v162, v163
    v_cvt_pk_bf16_f32 v50, v164, v165
    v_cvt_pk_bf16_f32 v51, v166, v167
    v_cvt_pk_bf16_f32 v52, v176, v177
    v_cvt_pk_bf16_f32 v53, v178, v179
    v_cvt_pk_bf16_f32 v54, v180, v181
    v_cvt_pk_bf16_f32 v55, v182, v183
    buffer_store_dwordx4 v[48:51], v10, s[20:23], s64 offen offset:2048 sc0 sc1
    buffer_store_dwordx4 v[52:55], v10, s[20:23], s65 offen offset:2048 sc0 sc1
    v_pk_mul_f32 v[56:57], v[192:193], v[192:193]
    v_pk_mul_f32 v[58:59], v[194:195], v[194:195]
    v_pk_mul_f32 v[60:61], v[196:197], v[196:197]
    v_pk_mul_f32 v[62:63], v[198:199], v[198:199]
    v_pk_mul_f32 v[64:65], v[208:209], v[208:209]
    v_pk_mul_f32 v[66:67], v[210:211], v[210:211]
    v_pk_mul_f32 v[68:69], v[212:213], v[212:213]
    v_pk_mul_f32 v[70:71], v[214:215], v[214:215]
    v_pk_fma_f32 v[56:57], v[56:57], v[12:13], v[12:13] op_sel:[0,0,1] op_sel_hi:[1,0,1]
    v_pk_fma_f32 v[58:59], v[58:59], v[12:13], v[12:13] op_sel:[0,0,1] op_sel_hi:[1,0,1]
    v_pk_fma_f32 v[60:61], v[60:61], v[12:13], v[12:13] op_sel:[0,0,1] op_sel_hi:[1,0,1]
    v_pk_fma_f32 v[62:63], v[62:63], v[12:13], v[12:13] op_sel:[0,0,1] op_sel_hi:[1,0,1]
    v_pk_fma_f32 v[64:65], v[64:65], v[12:13], v[12:13] op_sel:[0,0,1] op_sel_hi:[1,0,1]
    v_pk_fma_f32 v[66:67], v[66:67], v[12:13], v[12:13] op_sel:[0,0,1] op_sel_hi:[1,0,1]
    v_pk_fma_f32 v[68:69], v[68:69], v[12:13], v[12:13] op_sel:[0,0,1] op_sel_hi:[1,0,1]
    v_pk_fma_f32 v[70:71], v[70:71], v[12:13], v[12:13] op_sel:[0,0,1] op_sel_hi:[1,0,1]
    v_pk_mul_f32 v[56:57], v[56:57], v[192:193]
    v_pk_mul_f32 v[58:59], v[58:59], v[194:195]
    v_pk_mul_f32 v[60:61], v[60:61], v[196:197]
    v_pk_mul_f32 v[62:63], v[62:63], v[198:199]
    v_pk_mul_f32 v[64:65], v[64:65], v[208:209]
    v_pk_mul_f32 v[66:67], v[66:67], v[210:211]
    v_pk_mul_f32 v[68:69], v[68:69], v[212:213]
    v_pk_mul_f32 v[70:71], v[70:71], v[214:215]
    v_exp_f32 v56, v56
    v_exp_f32 v57, v57
    v_exp_f32 v58, v58
    v_exp_f32 v59, v59
    v_exp_f32 v60, v60
    v_exp_f32 v61, v61
    v_exp_f32 v62, v62
    v_exp_f32 v63, v63
    v_exp_f32 v64, v64
    v_exp_f32 v65, v65
    v_exp_f32 v66, v66
    v_exp_f32 v67, v67
    v_exp_f32 v68, v68
    v_exp_f32 v69, v69
    v_exp_f32 v70, v70
    v_exp_f32 v71, v71
    v_pk_mul_f32 v[192:193], v[192:193], v[200:201]
    v_pk_mul_f32 v[194:195], v[194:195], v[202:203]
    v_pk_mul_f32 v[196:197], v[196:197], v[204:205]
    v_pk_mul_f32 v[198:199], v[198:199], v[206:207]
    v_pk_mul_f32 v[208:209], v[208:209], v[216:217]
    v_pk_mul_f32 v[210:211], v[210:211], v[218:219]
    v_pk_mul_f32 v[212:213], v[212:213], v[220:221]
    v_pk_mul_f32 v[214:215], v[214:215], v[222:223]
    v_pk_add_f32 v[56:57], v[56:57], 1.0 op_sel_hi:[1,0]
    v_pk_add_f32 v[58:59], v[58:59], 1.0 op_sel_hi:[1,0]
    v_pk_add_f32 v[60:61], v[60:61], 1.0 op_sel_hi:[1,0]
    v_pk_add_f32 v[62:63], v[62:63], 1.0 op_sel_hi:[1,0]
    v_pk_add_f32 v[64:65], v[64:65], 1.0 op_sel_hi:[1,0]
    v_pk_add_f32 v[66:67], v[66:67], 1.0 op_sel_hi:[1,0]
    v_pk_add_f32 v[68:69], v[68:69], 1.0 op_sel_hi:[1,0]
    v_pk_add_f32 v[70:71], v[70:71], 1.0 op_sel_hi:[1,0]
    v_rcp_f32 v56, v56
    v_rcp_f32 v57, v57
    v_rcp_f32 v58, v58
    v_rcp_f32 v59, v59
    v_rcp_f32 v60, v60
    v_rcp_f32 v61, v61
    v_rcp_f32 v62, v62
    v_rcp_f32 v63, v63
    v_rcp_f32 v64, v64
    v_rcp_f32 v65, v65
    v_rcp_f32 v66, v66
    v_rcp_f32 v67, v67
    v_rcp_f32 v68, v68
    v_rcp_f32 v69, v69
    v_rcp_f32 v70, v70
    v_rcp_f32 v71, v71
    v_pk_mul_f32 v[192:193], v[192:193], v[56:57]
    v_pk_mul_f32 v[194:195], v[194:195], v[58:59]
    v_pk_mul_f32 v[196:197], v[196:197], v[60:61]
    v_pk_mul_f32 v[198:199], v[198:199], v[62:63]
    v_pk_mul_f32 v[208:209], v[208:209], v[64:65]
    v_pk_mul_f32 v[210:211], v[210:211], v[66:67]
    v_pk_mul_f32 v[212:213], v[212:213], v[68:69]
    v_pk_mul_f32 v[214:215], v[214:215], v[70:71]
    v_cvt_pk_bf16_f32 v72, v192, v193
    v_cvt_pk_bf16_f32 v73, v194, v195
    v_cvt_pk_bf16_f32 v74, v196, v197
    v_cvt_pk_bf16_f32 v75, v198, v199
    v_cvt_pk_bf16_f32 v76, v208, v209
    v_cvt_pk_bf16_f32 v77, v210, v211
    v_cvt_pk_bf16_f32 v78, v212, v213
    v_cvt_pk_bf16_f32 v79, v214, v215
    buffer_store_dwordx4 v[72:75], v10, s[20:23], s64 offen offset:3072 sc0 sc1
    buffer_store_dwordx4 v[76:79], v10, s[20:23], s65 offen offset:3072 sc0 sc1
    s_cmp_eq_u32 s58, 1
    s_cbranch_scc0 K1_JOIN
    v_pk_mul_f32 v[32:33], v[224:225], v[224:225]
    v_pk_mul_f32 v[34:35], v[226:227], v[226:227]
    v_pk_mul_f32 v[36:37], v[228:229], v[228:229]
    v_pk_mul_f32 v[38:39], v[230:231], v[230:231]
    v_pk_fma_f32 v[32:33], v[32:33], v[12:13], v[12:13] op_sel:[0,0,1] op_sel_hi:[1,0,1]
    v_pk_fma_f32 v[34:35], v[34:35], v[12:13], v[12:13] op_sel:[0,0,1] op_sel_hi:[1,0,1]
    v_pk_fma_f32 v[36:37], v[36:37], v[12:13], v[12:13] op_sel:[0,0,1] op_sel_hi:[1,0,1]
    v_pk_fma_f32 v[38:39], v[38:39], v[12:13], v[12:13] op_sel:[0,0,1] op_sel_hi:[1,0,1]
    v_pk_mul_f32 v[32:33], v[32:33], v[224:225]
    v_pk_mul_f32 v[34:35], v[34:35], v[226:227]
    v_pk_mul_f32 v[36:37], v[36:37], v[228:229]
    v_pk_mul_f32 v[38:39], v[38:39], v[230:231]
    v_exp_f32 v32, v32
    v_exp_f32 v33, v33
    v_exp_f32 v34, v34
    v_exp_f32 v35, v35
    v_exp_f32 v36, v36
    v_exp_f32 v37, v37
    v_exp_f32 v38, v38
    v_exp_f32 v39, v39
    v_pk_mul_f32 v[224:225], v[224:225], v[232:233]
    v_pk_mul_f32 v[226:227], v[226:227], v[234:235]
    v_pk_mul_f32 v[228:229], v[228:229], v[236:237]
    v_pk_mul_f32 v[230:231], v[230:231], v[238:239]
    v_pk_add_f32 v[32:33], v[32:33], 1.0 op_sel_hi:[1,0]
    v_pk_add_f32 v[34:35], v[34:35], 1.0 op_sel_hi:[1,0]
    v_pk_add_f32 v[36:37], v[36:37], 1.0 op_sel_hi:[1,0]
    v_pk_add_f32 v[38:39], v[38:39], 1.0 op_sel_hi:[1,0]
    v_rcp_f32 v32, v32
    v_rcp_f32 v33, v33
    v_rcp_f32 v34, v34
    v_rcp_f32 v35, v35
    v_rcp_f32 v36, v36
    v_rcp_f32 v37, v37
    v_rcp_f32 v38, v38
    v_rcp_f32 v39, v39
    v_pk_mul_f32 v[224:225], v[224:225], v[32:33]
    v_pk_mul_f32 v[226:227], v[226:227], v[34:35]
    v_pk_mul_f32 v[228:229], v[228:229], v[36:37]
    v_pk_mul_f32 v[230:231], v[230:231], v[38:39]
    v_cvt_pk_bf16_f32 v48, v224, v225
    v_cvt_pk_bf16_f32 v49, v226, v227
    v_cvt_pk_bf16_f32 v50, v228, v229
    v_cvt_pk_bf16_f32 v51, v230, v231
    buffer_store_dwordx4 v[48:51], v10, s[20:23], s66 offen offset:0 sc0 sc1
    s_branch K1_JOIN
K1_EPI_Q:
    s_mov_b32 s68, 0x3fb8aa3b
    s_mov_b32 s69, 0x358637bd
    s_add_u32 s66, s64, 8192
    s_add_u32 s67, s65, 8192
    v_pk_mul_f32 v[32:33], v[96:97], s[68:69] op_sel_hi:[1,0]
    v_pk_mul_f32 v[34:35], v[98:99], s[68:69] op_sel_hi:[1,0]
    v_pk_mul_f32 v[36:37], v[100:101], s[68:69] op_sel_hi:[1,0]
    v_pk_mul_f32 v[38:39], v[102:103], s[68:69] op_sel_hi:[1,0]
    v_pk_mul_f32 v[40:41], v[104:105], s[68:69] op_sel_hi:[1,0]
    v_pk_mul_f32 v[42:43], v[106:107], s[68:69] op_sel_hi:[1,0]
    v_pk_mul_f32 v[44:45], v[108:109], s[68:69] op_sel_hi:[1,0]
    v_pk_mul_f32 v[46:47], v[110:111], s[68:69] op_sel_hi:[1,0]
    v_exp_f32_e64 v32, v32 clamp
    v_exp_f32_e64 v33, v33 clamp
    v_exp_f32_e64 v34, v34 clamp
    v_exp_f32_e64 v35, v35 clamp
    v_exp_f32_e64 v36, v36 clamp
    v_exp_f32_e64 v37, v37 clamp
    v_exp_f32_e64 v38, v38 clamp
    v_exp_f32_e64 v39, v39 clamp
    v_exp_f32_e64 v40, v40 clamp
    v_exp_f32_e64 v41, v41 clamp
    v_exp_f32_e64 v42, v42 clamp
    v_exp_f32_e64 v43, v43 clamp
    v_exp_f32_e64 v44, v44 clamp
    v_exp_f32_e64 v45, v45 clamp
    v_exp_f32_e64 v46, v46 clamp
    v_exp_f32_e64 v47, v47 clamp
    v_max_f32 v96, s69, v96
    v_max_f32 v97, s69, v97
    v_max_f32 v98, s69, v98
    v_max_f32 v99, s69, v99
    v_max_f32 v100, s69, v100
    v_max_f32 v101, s69, v101
    v_max_f32 v102, s69, v102
    v_max_f32 v103, s69, v103
    v_max_f32 v104, s69, v104
    v_max_f32 v105, s69, v105
    v_max_f32 v106, s69, v106
    v_max_f32 v107, s69, v107
    v_max_f32 v108, s69, v108
    v_max_f32 v109, s69, v109
    v_max_f32 v110, s69, v110
    v_max_f32 v111, s69, v111
    v_pk_add_f32 v[96:97], v[96:97], v[32:33]
    v_pk_add_f32 v[98:99], v[98:99], v[34:35]
    v_pk_add_f32 v[100:101], v[100:101], v[36:37]
    v_pk_add_f32 v[102:103], v[102:103], v[38:39]
    v_pk_add_f32 v[104:105], v[104:105], v[40:41]
    v_pk_add_f32 v[106:107], v[106:107], v[42:43]
    v_pk_add_f32 v[108:109], v[108:109], v[44:45]
    v_pk_add_f32 v[110:111], v[110:111], v[46:47]
    v_cvt_pk_bf16_f32 v96, v96, v97
    v_cvt_pk_bf16_f32 v97, v98, v99
    v_cvt_pk_bf16_f32 v98, v100, v101
    v_cvt_pk_bf16_f32 v99, v102, v103
    v_cvt_pk_bf16_f32 v100, v104, v105
    v_cvt_pk_bf16_f32 v101, v106, v107
    v_cvt_pk_bf16_f32 v102, v108, v109
    v_cvt_pk_bf16_f32 v103, v110, v111
    buffer_store_dwordx4 v[96:99], v10, s[20:23], s64 offen offset:0 sc0 sc1
    buffer_store_dwordx4 v[100:103], v10, s[20:23], s66 offen offset:0 sc0 sc1
    v_pk_mul_f32 v[32:33], v[112:113], s[68:69] op_sel_hi:[1,0]
    v_pk_mul_f32 v[34:35], v[114:115], s[68:69] op_sel_hi:[1,0]
    v_pk_mul_f32 v[36:37], v[116:117], s[68:69] op_sel_hi:[1,0]
    v_pk_mul_f32 v[38:39], v[118:119], s[68:69] op_sel_hi:[1,0]
    v_pk_mul_f32 v[40:41], v[120:121], s[68:69] op_sel_hi:[1,0]
    v_pk_mul_f32 v[42:43], v[122:123], s[68:69] op_sel_hi:[1,0]
    v_pk_mul_f32 v[44:45], v[124:125], s[68:69] op_sel_hi:[1,0]
    v_pk_mul_f32 v[46:47], v[126:127], s[68:69] op_sel_hi:[1,0]
    v_exp_f32_e64 v32, v32 clamp
    v_exp_f32_e64 v33, v33 clamp
    v_exp_f32_e64 v34, v34 clamp
    v_exp_f32_e64 v35, v35 clamp
    v_exp_f32_e64 v36, v36 clamp
    v_exp_f32_e64 v37, v37 clamp
    v_exp_f32_e64 v38, v38 clamp
    v_exp_f32_e64 v39, v39 clamp
    v_exp_f32_e64 v40, v40 clamp
    v_exp_f32_e64 v41, v41 clamp
    v_exp_f32_e64 v42, v42 clamp
    v_exp_f32_e64 v43, v43 clamp
    v_exp_f32_e64 v44, v44 clamp
    v_exp_f32_e64 v45, v45 clamp
    v_exp_f32_e64 v46, v46 clamp
    v_exp_f32_e64 v47, v47 clamp
    v_max_f32 v112, s69, v112
    v_max_f32 v113, s69, v113
    v_max_f32 v114, s69, v114
    v_max_f32 v115, s69, v115
    v_max_f32 v116, s69, v116
    v_max_f32 v117, s69, v117
    v_max_f32 v118, s69, v118
    v_max_f32 v119, s69, v119
    v_max_f32 v120, s69, v120
    v_max_f32 v121, s69, v121
    v_max_f32 v122, s69, v122
    v_max_f32 v123, s69, v123
    v_max_f32 v124, s69, v124
    v_max_f32 v125, s69, v125
    v_max_f32 v126, s69, v126
    v_max_f32 v127, s69, v127
    v_pk_add_f32 v[112:113], v[112:113], v[32:33]
    v_pk_add_f32 v[114:115], v[114:115], v[34:35]
    v_pk_add_f32 v[116:117], v[116:117], v[36:37]
    v_pk_add_f32 v[118:119], v[118:119], v[38:39]
    v_pk_add_f32 v[120:121], v[120:121], v[40:41]
    v_pk_add_f32 v[122:123], v[122:123], v[42:43]
    v_pk_add_f32 v[124:125], v[124:125], v[44:45]
    v_pk_add_f32 v[126:127], v[126:127], v[46:47]
    v_cvt_pk_bf16_f32 v112, v112, v113
    v_cvt_pk_bf16_f32 v113, v114, v115
    v_cvt_pk_bf16_f32 v114, v116, v117
    v_cvt_pk_bf16_f32 v115, v118, v119
    v_cvt_pk_bf16_f32 v116, v120, v121
    v_cvt_pk_bf16_f32 v117, v122, v123
    v_cvt_pk_bf16_f32 v118, v124, v125
    v_cvt_pk_bf16_f32 v119, v126, v127
    buffer_store_dwordx4 v[112:115], v10, s[20:23], s65 offen offset:0 sc0 sc1
    buffer_store_dwordx4 v[116:119], v10, s[20:23], s67 offen offset:0 sc0 sc1
    v_pk_mul_f32 v[32:33], v[128:129], s[68:69] op_sel_hi:[1,0]
    v_pk_mul_f32 v[34:35], v[130:131], s[68:69] op_sel_hi:[1,0]
    v_pk_mul_f32 v[36:37], v[132:133], s[68:69] op_sel_hi:[1,0]
    v_pk_mul_f32 v[38:39], v[134:135], s[68:69] op_sel_hi:[1,0]
    v_pk_mul_f32 v[40:41], v[136:137], s[68:69] op_sel_hi:[1,0]
    v_pk_mul_f32 v[42:43], v[138:139], s[68:69] op_sel_hi:[1,0]
    v_pk_mul_f32 v[44:45], v[140:141], s[68:69] op_sel_hi:[1,0]
    v_pk_mul_f32 v[46:47], v[142:143], s[68:69] op_sel_hi:[1,0]
    v_exp_f32_e64 v32, v32 clamp
    v_exp_f32_e64 v33, v33 clamp
    v_exp_f32_e64 v34, v34 clamp
    v_exp_f32_e64 v35, v35 clamp
    v_exp_f32_e64 v36, v36 clamp
    v_exp_f32_e64 v37, v37 clamp
    v_exp_f32_e64 v38, v38 clamp
    v_exp_f32_e64 v39, v39 clamp
    v_exp_f32_e64 v40, v40 clamp
    v_exp_f32_e64 v41, v41 clamp
    v_exp_f32_e64 v42, v42 clamp
    v_exp_f32_e64 v43, v43 clamp
    v_exp_f32_e64 v44, v44 clamp
    v_exp_f32_e64 v45, v45 clamp
    v_exp_f32_e64 v46, v46 clamp
    v_exp_f32_e64 v47, v47 clamp
    v_max_f32 v128, s69, v128
    v_max_f32 v129, s69, v129
    v_max_f32 v130, s69, v130
    v_max_f32 v131, s69, v131
    v_max_f32 v132, s69, v132
    v_max_f32 v133, s69, v133
    v_max_f32 v134, s69, v134
    v_max_f32 v135, s69, v135
    v_max_f32 v136, s69, v136
    v_max_f32 v137, s69, v137
    v_max_f32 v138, s69, v138
    v_max_f32 v139, s69, v139
    v_max_f32 v140, s69, v140
    v_max_f32 v141, s69, v141
    v_max_f32 v142, s69, v142
    v_max_f32 v143, s69, v143
    v_pk_add_f32 v[128:129], v[128:129], v[32:33]
    v_pk_add_f32 v[130:131], v[130:131], v[34:35]
    v_pk_add_f32 v[132:133], v[132:133], v[36:37]
    v_pk_add_f32 v[134:135], v[134:135], v[38:39]
    v_pk_add_f32 v[136:137], v[136:137], v[40:41]
    v_pk_add_f32 v[138:139], v[138:139], v[42:43]
    v_pk_add_f32 v[140:141], v[140:141], v[44:45]
    v_pk_add_f32 v[142:143], v[142:143], v[46:47]
    v_cvt_pk_bf16_f32 v128, v128, v129
    v_cvt_pk_bf16_f32 v129, v130, v131
    v_cvt_pk_bf16_f32 v130, v132, v133
    v_cvt_pk_bf16_f32 v131, v134, v135
    v_cvt_pk_bf16_f32 v132, v136, v137
    v_cvt_pk_bf16_f32 v133, v138, v139
    v_cvt_pk_bf16_f32 v134, v140, v141
    v_cvt_pk_bf16_f32 v135, v142, v143
    buffer_store_dwordx4 v[128:131], v10, s[20:23], s64 offen offset:1024 sc0 sc1
    buffer_store_dwordx4 v[132:135], v10, s[20:23], s66 offen offset:1024 sc0 sc1
    v_pk_mul_f32 v[32:33], v[144:145], s[68:69] op_sel_hi:[1,0]
    v_pk_mul_f32 v[34:35], v[146:147], s[68:69] op_sel_hi:[1,0]
    v_pk_mul_f32 v[36:37], v[148:149], s[68:69] op_sel_hi:[1,0]
    v_pk_mul_f32 v[38:39], v[150:151], s[68:69] op_sel_hi:[1,0]
    v_pk_mul_f32 v[40:41], v[152:153], s[68:69] op_sel_hi:[1,0]
    v_pk_mul_f32 v[42:43], v[154:155], s[68:69] op_sel_hi:[1,0]
    v_pk_mul_f32 v[44:45], v[156:157], s[68:69] op_sel_hi:[1,0]
    v_pk_mul_f32 v[46:47], v[158:159], s[68:69] op_sel_hi:[1,0]
    v_exp_f32_e64 v32, v32 clamp
    v_exp_f32_e64 v33, v33 clamp
    v_exp_f32_e64 v34, v34 clamp
    v_exp_f32_e64 v35, v35 clamp
    v_exp_f32_e64 v36, v36 clamp
    v_exp_f32_e64 v37, v37 clamp
    v_exp_f32_e64 v38, v38 clamp
    v_exp_f32_e64 v39, v39 clamp
    v_exp_f32_e64 v40, v40 clamp
    v_exp_f32_e64 v41, v41 clamp
    v_exp_f32_e64 v42, v42 clamp
    v_exp_f32_e64 v43, v43 clamp
    v_exp_f32_e64 v44, v44 clamp
    v_exp_f32_e64 v45, v45 clamp
    v_exp_f32_e64 v46, v46 clamp
    v_exp_f32_e64 v47, v47 clamp
    v_max_f32 v144, s69, v144
    v_max_f32 v145, s69, v145
    v_max_f32 v146, s69, v146
    v_max_f32 v147, s69, v147
    v_max_f32 v148, s69, v148
    v_max_f32 v149, s69, v149
    v_max_f32 v150, s69, v150
    v_max_f32 v151, s69, v151
    v_max_f32 v152, s69, v152
    v_max_f32 v153, s69, v153
    v_max_f32 v154, s69, v154
    v_max_f32 v155, s69, v155
    v_max_f32 v156, s69, v156
    v_max_f32 v157, s69, v157
    v_max_f32 v158, s69, v158
    v_max_f32 v159, s69, v159
    v_pk_add_f32 v[144:145], v[144:145], v[32:33]
    v_pk_add_f32 v[146:147], v[146:147], v[34:35]
    v_pk_add_f32 v[148:149], v[148:149], v[36:37]
    v_pk_add_f32 v[150:151], v[150:151], v[38:39]
    v_pk_add_f32 v[152:153], v[152:153], v[40:41]
    v_pk_add_f32 v[154:155], v[154:155], v[42:43]
    v_pk_add_f32 v[156:157], v[156:157], v[44:45]
    v_pk_add_f32 v[158:159], v[158:159], v[46:47]
    v_cvt_pk_bf16_f32 v144, v144, v145
    v_cvt_pk_bf16_f32 v145, v146, v147
    v_cvt_pk_bf16_f32 v146, v148, v149
    v_cvt_pk_bf16_f32 v147, v150, v151
    v_cvt_pk_bf16_f32 v148, v152, v153
    v_cvt_pk_bf16_f32 v149, v154, v155
    v_cvt_pk_bf16_f32 v150, v156, v157
    v_cvt_pk_bf16_f32 v151, v158, v159
    buffer_store_dwordx4 v[144:147], v10, s[20:23], s65 offen offset:1024 sc0 sc1
    buffer_store_dwordx4 v[148:151], v10, s[20:23], s67 offen offset:1024 sc0 sc1
    v_pk_mul_f32 v[32:33], v[160:161], s[68:69] op_sel_hi:[1,0]
    v_pk_mul_f32 v[34:35], v[162:163], s[68:69] op_sel_hi:[1,0]
    v_pk_mul_f32 v[36:37], v[164:165], s[68:69] op_sel_hi:[1,0]
    v_pk_mul_f32 v[38:39], v[166:167], s[68:69] op_sel_hi:[1,0]
    v_pk_mul_f32 v[40:41], v[168:169], s[68:69] op_sel_hi:[1,0]
    v_pk_mul_f32 v[42:43], v[170:171], s[68:69] op_sel_hi:[1,0]
    v_pk_mul_f32 v[44:45], v[172:173], s[68:69] op_sel_hi:[1,0]
    v_pk_mul_f32 v[46:47], v[174:175], s[68:69] op_sel_hi:[1,0]
    v_exp_f32_e64 v32, v32 clamp
    v_exp_f32_e64 v33, v33 clamp
    v_exp_f32_e64 v34, v34 clamp
    v_exp_f32_e64 v35, v35 clamp
    v_exp_f32_e64 v36, v36 clamp
    v_exp_f32_e64 v37, v37 clamp
    v_exp_f32_e64 v38, v38 clamp
    v_exp_f32_e64 v39, v39 clamp
    v_exp_f32_e64 v40, v40 clamp
    v_exp_f32_e64 v41, v41 clamp
    v_exp_f32_e64 v42, v42 clamp
    v_exp_f32_e64 v43, v43 clamp
    v_exp_f32_e64 v44, v44 clamp
    v_exp_f32_e64 v45, v45 clamp
    v_exp_f32_e64 v46, v46 clamp
    v_exp_f32_e64 v47, v47 clamp
    v_max_f32 v160, s69, v160
    v_max_f32 v161, s69, v161
    v_max_f32 v162, s69, v162
    v_max_f32 v163, s69, v163
    v_max_f32 v164, s69, v164
    v_max_f32 v165, s69, v165
    v_max_f32 v166, s69, v166
    v_max_f32 v167, s69, v167
    v_max_f32 v168, s69, v168
    v_max_f32 v169, s69, v169
    v_max_f32 v170, s69, v170
    v_max_f32 v171, s69, v171
    v_max_f32 v172, s69, v172
    v_max_f32 v173, s69, v173
    v_max_f32 v174, s69, v174
    v_max_f32 v175, s69, v175
    v_pk_add_f32 v[160:161], v[160:161], v[32:33]
    v_pk_add_f32 v[162:163], v[162:163], v[34:35]
    v_pk_add_f32 v[164:165], v[164:165], v[36:37]
    v_pk_add_f32 v[166:167], v[166:167], v[38:39]
    v_pk_add_f32 v[168:169], v[168:169], v[40:41]
    v_pk_add_f32 v[170:171], v[170:171], v[42:43]
    v_pk_add_f32 v[172:173], v[172:173], v[44:45]
    v_pk_add_f32 v[174:175], v[174:175], v[46:47]
    v_cvt_pk_bf16_f32 v160, v160, v161
    v_cvt_pk_bf16_f32 v161, v162, v163
    v_cvt_pk_bf16_f32 v162, v164, v165
    v_cvt_pk_bf16_f32 v163, v166, v167
    v_cvt_pk_bf16_f32 v164, v168, v169
    v_cvt_pk_bf16_f32 v165, v170, v171
    v_cvt_pk_bf16_f32 v166, v172, v173
    v_cvt_pk_bf16_f32 v167, v174, v175
    buffer_store_dwordx4 v[160:163], v10, s[20:23], s64 offen offset:2048 sc0 sc1
    buffer_store_dwordx4 v[164:167], v10, s[20:23], s66 offen offset:2048 sc0 sc1
    v_pk_mul_f32 v[32:33], v[176:177], s[68:69] op_sel_hi:[1,0]
    v_pk_mul_f32 v[34:35], v[178:179], s[68:69] op_sel_hi:[1,0]
    v_pk_mul_f32 v[36:37], v[180:181], s[68:69] op_sel_hi:[1,0]
    v_pk_mul_f32 v[38:39], v[182:183], s[68:69] op_sel_hi:[1,0]
    v_pk_mul_f32 v[40:41], v[184:185], s[68:69] op_sel_hi:[1,0]
    v_pk_mul_f32 v[42:43], v[186:187], s[68:69] op_sel_hi:[1,0]
    v_pk_mul_f32 v[44:45], v[188:189], s[68:69] op_sel_hi:[1,0]
    v_pk_mul_f32 v[46:47], v[190:191], s[68:69] op_sel_hi:[1,0]
    v_exp_f32_e64 v32, v32 clamp
    v_exp_f32_e64 v33, v33 clamp
    v_exp_f32_e64 v34, v34 clamp
    v_exp_f32_e64 v35, v35 clamp
    v_exp_f32_e64 v36, v36 clamp
    v_exp_f32_e64 v37, v37 clamp
    v_exp_f32_e64 v38, v38 clamp
    v_exp_f32_e64 v39, v39 clamp
    v_exp_f32_e64 v40, v40 clamp
    v_exp_f32_e64 v41, v41 clamp
    v_exp_f32_e64 v42, v42 clamp
    v_exp_f32_e64 v43, v43 clamp
    v_exp_f32_e64 v44, v44 clamp
    v_exp_f32_e64 v45, v45 clamp
    v_exp_f32_e64 v46, v46 clamp
    v_exp_f32_e64 v47, v47 clamp
    v_max_f32 v176, s69, v176
    v_max_f32 v177, s69, v177
    v_max_f32 v178, s69, v178
    v_max_f32 v179, s69, v179
    v_max_f32 v180, s69, v180
    v_max_f32 v181, s69, v181
    v_max_f32 v182, s69, v182
    v_max_f32 v183, s69, v183
    v_max_f32 v184, s69, v184
    v_max_f32 v185, s69, v185
    v_max_f32 v186, s69, v186
    v_max_f32 v187, s69, v187
    v_max_f32 v188, s69, v188
    v_max_f32 v189, s69, v189
    v_max_f32 v190, s69, v190
    v_max_f32 v191, s69, v191
    v_pk_add_f32 v[176:177], v[176:177], v[32:33]
    v_pk_add_f32 v[178:179], v[178:179], v[34:35]
    v_pk_add_f32 v[180:181], v[180:181], v[36:37]
    v_pk_add_f32 v[182:183], v[182:183], v[38:39]
    v_pk_add_f32 v[184:185], v[184:185], v[40:41]
    v_pk_add_f32 v[186:187], v[186:187], v[42:43]
    v_pk_add_f32 v[188:189], v[188:189], v[44:45]
    v_pk_add_f32 v[190:191], v[190:191], v[46:47]
    v_cvt_pk_bf16_f32 v176, v176, v177
    v_cvt_pk_bf16_f32 v177, v178, v179
    v_cvt_pk_bf16_f32 v178, v180, v181
    v_cvt_pk_bf16_f32 v179, v182, v183
    v_cvt_pk_bf16_f32 v180, v184, v185
    v_cvt_pk_bf16_f32 v181, v186, v187
    v_cvt_pk_bf16_f32 v182, v188, v189
    v_cvt_pk_bf16_f32 v183, v190, v191
    buffer_store_dwordx4 v[176:179], v10, s[20:23], s65 offen offset:2048 sc0 sc1
    buffer_store_dwordx4 v[180:183], v10, s[20:23], s67 offen offset:2048 sc0 sc1
    v_pk_mul_f32 v[32:33], v[192:193], s[68:69] op_sel_hi:[1,0]
    v_pk_mul_f32 v[34:35], v[194:195], s[68:69] op_sel_hi:[1,0]
    v_pk_mul_f32 v[36:37], v[196:197], s[68:69] op_sel_hi:[1,0]
    v_pk_mul_f32 v[38:39], v[198:199], s[68:69] op_sel_hi:[1,0]
    v_pk_mul_f32 v[40:41], v[200:201], s[68:69] op_sel_hi:[1,0]
    v_pk_mul_f32 v[42:43], v[202:203], s[68:69] op_sel_hi:[1,0]
    v_pk_mul_f32 v[44:45], v[204:205], s[68:69] op_sel_hi:[1,0]
    v_pk_mul_f32 v[46:47], v[206:207], s[68:69] op_sel_hi:[1,0]
    v_exp_f32_e64 v32, v32 clamp
    v_exp_f32_e64 v33, v33 clamp
    v_exp_f32_e64 v34, v34 clamp
    v_exp_f32_e64 v35, v35 clamp
    v_exp_f32_e64 v36, v36 clamp
    v_exp_f32_e64 v37, v37 clamp
    v_exp_f32_e64 v38, v38 clamp
    v_exp_f32_e64 v39, v39 clamp
    v_exp_f32_e64 v40, v40 clamp
    v_exp_f32_e64 v41, v41 clamp
    v_exp_f32_e64 v42, v42 clamp
    v_exp_f32_e64 v43, v43 clamp
    v_exp_f32_e64 v44, v44 clamp
    v_exp_f32_e64 v45, v45 clamp
    v_exp_f32_e64 v46, v46 clamp
    v_exp_f32_e64 v47, v47 clamp
    v_max_f32 v192, s69, v192
    v_max_f32 v193, s69, v193
    v_max_f32 v194, s69, v194
    v_max_f32 v195, s69, v195
    v_max_f32 v196, s69, v196
    v_max_f32 v197, s69, v197
    v_max_f32 v198, s69, v198
    v_max_f32 v199, s69, v199
    v_max_f32 v200, s69, v200
    v_max_f32 v201, s69, v201
    v_max_f32 v202, s69, v202
    v_max_f32 v203, s69, v203
    v_max_f32 v204, s69, v204
    v_max_f32 v205, s69, v205
    v_max_f32 v206, s69, v206
    v_max_f32 v207, s69, v207
    v_pk_add_f32 v[192:193], v[192:193], v[32:33]
    v_pk_add_f32 v[194:195], v[194:195], v[34:35]
    v_pk_add_f32 v[196:197], v[196:197], v[36:37]
    v_pk_add_f32 v[198:199], v[198:199], v[38:39]
    v_pk_add_f32 v[200:201], v[200:201], v[40:41]
    v_pk_add_f32 v[202:203], v[202:203], v[42:43]
    v_pk_add_f32 v[204:205], v[204:205], v[44:45]
    v_pk_add_f32 v[206:207], v[206:207], v[46:47]
    v_cvt_pk_bf16_f32 v192, v192, v193
    v_cvt_pk_bf16_f32 v193, v194, v195
    v_cvt_pk_bf16_f32 v194, v196, v197
    v_cvt_pk_bf16_f32 v195, v198, v199
    v_cvt_pk_bf16_f32 v196, v200, v201
    v_cvt_pk_bf16_f32 v197, v202, v203
    v_cvt_pk_bf16_f32 v198, v204, v205
    v_cvt_pk_bf16_f32 v199, v206, v207
    buffer_store_dwordx4 v[192:195], v10, s[20:23], s64 offen offset:3072 sc0 sc1
    buffer_store_dwordx4 v[196:199], v10, s[20:23], s66 offen offset:3072 sc0 sc1
    v_pk_mul_f32 v[32:33], v[208:209], s[68:69] op_sel_hi:[1,0]
    v_pk_mul_f32 v[34:35], v[210:211], s[68:69] op_sel_hi:[1,0]
    v_pk_mul_f32 v[36:37], v[212:213], s[68:69] op_sel_hi:[1,0]
    v_pk_mul_f32 v[38:39], v[214:215], s[68:69] op_sel_hi:[1,0]
    v_pk_mul_f32 v[40:41], v[216:217], s[68:69] op_sel_hi:[1,0]
    v_pk_mul_f32 v[42:43], v[218:219], s[68:69] op_sel_hi:[1,0]
    v_pk_mul_f32 v[44:45], v[220:221], s[68:69] op_sel_hi:[1,0]
    v_pk_mul_f32 v[46:47], v[222:223], s[68:69] op_sel_hi:[1,0]
    v_exp_f32_e64 v32, v32 clamp
    v_exp_f32_e64 v33, v33 clamp
    v_exp_f32_e64 v34, v34 clamp
    v_exp_f32_e64 v35, v35 clamp
    v_exp_f32_e64 v36, v36 clamp
    v_exp_f32_e64 v37, v37 clamp
    v_exp_f32_e64 v38, v38 clamp
    v_exp_f32_e64 v39, v39 clamp
    v_exp_f32_e64 v40, v40 clamp
    v_exp_f32_e64 v41, v41 clamp
    v_exp_f32_e64 v42, v42 clamp
    v_exp_f32_e64 v43, v43 clamp
    v_exp_f32_e64 v44, v44 clamp
    v_exp_f32_e64 v45, v45 clamp
    v_exp_f32_e64 v46, v46 clamp
    v_exp_f32_e64 v47, v47 clamp
    v_max_f32 v208, s69, v208
    v_max_f32 v209, s69, v209
    v_max_f32 v210, s69, v210
    v_max_f32 v211, s69, v211
    v_max_f32 v212, s69, v212
    v_max_f32 v213, s69, v213
    v_max_f32 v214, s69, v214
    v_max_f32 v215, s69, v215
    v_max_f32 v216, s69, v216
    v_max_f32 v217, s69, v217
    v_max_f32 v218, s69, v218
    v_max_f32 v219, s69, v219
    v_max_f32 v220, s69, v220
    v_max_f32 v221, s69, v221
    v_max_f32 v222, s69, v222
    v_max_f32 v223, s69, v223
    v_pk_add_f32 v[208:209], v[208:209], v[32:33]
    v_pk_add_f32 v[210:211], v[210:211], v[34:35]
    v_pk_add_f32 v[212:213], v[212:213], v[36:37]
    v_pk_add_f32 v[214:215], v[214:215], v[38:39]
    v_pk_add_f32 v[216:217], v[216:217], v[40:41]
    v_pk_add_f32 v[218:219], v[218:219], v[42:43]
    v_pk_add_f32 v[220:221], v[220:221], v[44:45]
    v_pk_add_f32 v[222:223], v[222:223], v[46:47]
    v_cvt_pk_bf16_f32 v208, v208, v209
    v_cvt_pk_bf16_f32 v209, v210, v211
    v_cvt_pk_bf16_f32 v210, v212, v213
    v_cvt_pk_bf16_f32 v211, v214, v215
    v_cvt_pk_bf16_f32 v212, v216, v217
    v_cvt_pk_bf16_f32 v213, v218, v219
    v_cvt_pk_bf16_f32 v214, v220, v221
    v_cvt_pk_bf16_f32 v215, v222, v223
    buffer_store_dwordx4 v[208:211], v10, s[20:23], s65 offen offset:3072 sc0 sc1
    buffer_store_dwordx4 v[212:215], v10, s[20:23], s67 offen offset:3072 sc0 sc1
    s_branch K1_JOIN
K1_EPI_KV:
    s_mov_b32 s68, 0x3fb8aa3b
    s_mov_b32 s69, 0x358637bd
    v_mov_b32 v80, s55
    v_mov_b32 v81, s55
    v_mov_b32 v82, s55
    v_mov_b32 v83, s55
    v_and_b32 v3, 3, v1
    v_bfe_u32 v4, v1, 2, 1
    v_lshl_add_u32 v3, v4, 3, v3
    v_bfe_u32 v4, v1, 3, 1
    v_lshl_add_u32 v3, v4, 2, v3
    v_lshrrev_b32 v4, 5, v1
    v_lshl_add_u32 v3, v4, 6, v3
    v_bfe_u32 v4, v1, 4, 1
    v_lshlrev_b32 v3, 2, v3
    v_lshl_add_u32 v5, v4, 8, v3
    v_lshl_add_u32 v3, v4, 12, v3
    s_sub_u32 s3, s44, 10
    s_lshl3_add_u32 s3, s3, s52
    s_lshl_b32 s64, s3, 10
    s_add_u32 s64, s64, 8388608
    s_lshl_b32 s65, s3, 6
    s_add_u32 s65, s65, 8421376
    s_mov_b32 s66, 0xffff0000
    s_mov_b32 s67, 0xffff0000
    v_pk_mul_f32 v[32:33], v[96:97], s[68:69] op_sel_hi:[1,0]
    v_pk_mul_f32 v[34:35], v[98:99], s[68:69] op_sel_hi:[1,0]
    v_pk_mul_f32 v[36:37], v[100:101], s[68:69] op_sel_hi:[1,0]
    v_pk_mul_f32 v[38:39], v[102:103], s[68:69] op_sel_hi:[1,0]
    v_pk_mul_f32 v[40:41], v[104:105], s[68:69] op_sel_hi:[1,0]
    v_pk_mul_f32 v[42:43], v[106:107], s[68:69] op_sel_hi:[1,0]
    v_pk_mul_f32 v[44:45], v[108:109], s[68:69] op_sel_hi:[1,0]
    v_pk_mul_f32 v[46:47], v[110:111], s[68:69] op_sel_hi:[1,0]
    v_exp_f32_e64 v32, v32 clamp
    v_exp_f32_e64 v33, v33 clamp
    v_exp_f32_e64 v34, v34 clamp
    v_exp_f32_e64 v35, v35 clamp
    v_exp_f32_e64 v36, v36 clamp
    v_exp_f32_e64 v37, v37 clamp
    v_exp_f32_e64 v38, v38 clamp
    v_exp_f32_e64 v39, v39 clamp
    v_exp_f32_e64 v40, v40 clamp
    v_exp_f32_e64 v41, v41 clamp
    v_exp_f32_e64 v42, v42 clamp
    v_exp_f32_e64 v43, v43 clamp
    v_exp_f32_e64 v44, v44 clamp
    v_exp_f32_e64 v45, v45 clamp
    v_exp_f32_e64 v46, v46 clamp
    v_exp_f32_e64 v47, v47 clamp
    v_max_f32 v96, s69, v96
    v_max_f32 v97, s69, v97
    v_max_f32 v98, s69, v98
    v_max_f32 v99, s69, v99
    v_max_f32 v100, s69, v100
    v_max_f32 v101, s69, v101
    v_max_f32 v102, s69, v102
    v_max_f32 v103, s69, v103
    v_max_f32 v104, s69, v104
    v_max_f32 v105, s69, v105
    v_max_f32 v106, s69, v106
    v_max_f32 v107, s69, v107
    v_max_f32 v108, s69, v108
    v_max_f32 v109, s69, v109
    v_max_f32 v110, s69, v110
    v_max_f32 v111, s69, v111
    v_cvt_pk_bf16_f32 v56, v160, v161
    v_cvt_pk_bf16_f32 v57, v162, v163
    v_cvt_pk_bf16_f32 v58, v164, v165
    v_cvt_pk_bf16_f32 v59, v166, v167
    v_cvt_pk_bf16_f32 v60, v168, v169
    v_cvt_pk_bf16_f32 v61, v170, v171
    v_cvt_pk_bf16_f32 v62, v172, v173
    v_cvt_pk_bf16_f32 v63, v174, v175
    v_pk_add_f32 v[96:97], v[96:97], v[32:33]
    v_pk_add_f32 v[98:99], v[98:99], v[34:35]
    v_pk_add_f32 v[100:101], v[100:101], v[36:37]
    v_pk_add_f32 v[102:103], v[102:103], v[38:39]
    v_pk_add_f32 v[104:105], v[104:105], v[40:41]
    v_pk_add_f32 v[106:107], v[106:107], v[42:43]
    v_pk_add_f32 v[108:109], v[108:109], v[44:45]
    v_pk_add_f32 v[110:111], v[110:111], v[46:47]
    v_cvt_pk_bf16_f32 v48, v96, v97
    v_cvt_pk_bf16_f32 v49, v98, v99
    v_cvt_pk_bf16_f32 v50, v100, v101
    v_cvt_pk_bf16_f32 v51, v102, v103
    v_cvt_pk_bf16_f32 v52, v104, v105
    v_cvt_pk_bf16_f32 v53, v106, v107
    v_cvt_pk_bf16_f32 v54, v108, v109
    v_cvt_pk_bf16_f32 v55, v110, v111
    v_pk_mul_f32 v[32:33], v[112:113], s[68:69] op_sel_hi:[1,0]
    v_pk_mul_f32 v[34:35], v[114:115], s[68:69] op_sel_hi:[1,0]
    v_pk_mul_f32 v[36:37], v[116:117], s[68:69] op_sel_hi:[1,0]
    v_pk_mul_f32 v[38:39], v[118:119], s[68:69] op_sel_hi:[1,0]
    v_pk_mul_f32 v[40:41], v[120:121], s[68:69] op_sel_hi:[1,0]
    v_pk_mul_f32 v[42:43], v[122:123], s[68:69] op_sel_hi:[1,0]
    v_pk_mul_f32 v[44:45], v[124:125], s[68:69] op_sel_hi:[1,0]
    v_pk_mul_f32 v[46:47], v[126:127], s[68:69] op_sel_hi:[1,0]
    v_mfma_f32_32x32x16_bf16 v[224:239], v[56:59], v[48:51], 0
    v_exp_f32_e64 v32, v32 clamp
    v_exp_f32_e64 v33, v33 clamp
    v_exp_f32_e64 v34, v34 clamp
    v_mfma_f32_32x32x16_bf16 v[224:239], v[60:63], v[52:55], v[224:239]
    v_exp_f32_e64 v35, v35 clamp
    v_exp_f32_e64 v36, v36 clamp
    v_exp_f32_e64 v37, v37 clamp
    v_mfma_f32_32x32x16_bf16 v[160:175], v[80:83], v[48:51], 0
    v_exp_f32_e64 v38, v38 clamp
    v_exp_f32_e64 v39, v39 clamp
    v_exp_f32_e64 v40, v40 clamp
    v_mfma_f32_32x32x16_bf16 v[160:175], v[80:83], v[52:55], v[160:175]
    v_exp_f32_e64 v41, v41 clamp
    v_exp_f32_e64 v42, v42 clamp
    v_exp_f32_e64 v43, v43 clamp
    v_exp_f32_e64 v44, v44 clamp
    v_exp_f32_e64 v45, v45 clamp
    v_exp_f32_e64 v46, v46 clamp
    v_exp_f32_e64 v47, v47 clamp
    v_max_f32 v112, s69, v112
    v_max_f32 v113, s69, v113
    v_max_f32 v114, s69, v114
    v_max_f32 v115, s69, v115
    v_max_f32 v116, s69, v116
    v_max_f32 v117, s69, v117
    v_max_f32 v118, s69, v118
    v_max_f32 v119, s69, v119
    v_max_f32 v120, s69, v120
    v_max_f32 v121, s69, v121
    v_max_f32 v122, s69, v122
    v_max_f32 v123, s69, v123
    v_max_f32 v124, s69, v124
    v_max_f32 v125, s69, v125
    v_max_f32 v126, s69, v126
    v_max_f32 v127, s69, v127
    v_cvt_pk_bf16_f32 v72, v176, v177
    v_cvt_pk_bf16_f32 v73, v178, v179
    v_cvt_pk_bf16_f32 v74, v180, v181
    v_cvt_pk_bf16_f32 v75, v182, v183
    v_cvt_pk_bf16_f32 v76, v184, v185
    v_cvt_pk_bf16_f32 v77, v186, v187
    v_cvt_pk_bf16_f32 v78, v188, v189
    v_cvt_pk_bf16_f32 v79, v190, v191
    v_pk_add_f32 v[112:113], v[112:113], v[32:33]
    v_pk_add_f32 v[114:115], v[114:115], v[34:35]
    v_pk_add_f32 v[116:117], v[116:117], v[36:37]
    v_pk_add_f32 v[118:119], v[118:119], v[38:39]
    v_pk_add_f32 v[120:121], v[120:121], v[40:41]
    v_pk_add_f32 v[122:123], v[122:123], v[42:43]
    v_pk_add_f32 v[124:125], v[124:125], v[44:45]
    v_pk_add_f32 v[126:127], v[126:127], v[46:47]
    v_cvt_pk_bf16_f32 v64, v112, v113
    v_cvt_pk_bf16_f32 v65, v114, v115
    v_cvt_pk_bf16_f32 v66, v116, v117
    v_cvt_pk_bf16_f32 v67, v118, v119
    v_cvt_pk_bf16_f32 v68, v120, v121
    v_cvt_pk_bf16_f32 v69, v122, v123
    v_cvt_pk_bf16_f32 v70, v124, v125
    v_cvt_pk_bf16_f32 v71, v126, v127
    v_pk_mul_f32 v[32:33], v[128:129], s[68:69] op_sel_hi:[1,0]
    v_pk_mul_f32 v[34:35], v[130:131], s[68:69] op_sel_hi:[1,0]
    v_pk_mul_f32 v[36:37], v[132:133], s[68:69] op_sel_hi:[1,0]
    v_pk_mul_f32 v[38:39], v[134:135], s[68:69] op_sel_hi:[1,0]
    v_pk_mul_f32 v[40:41], v[136:137], s[68:69] op_sel_hi:[1,0]
    v_pk_mul_f32 v[42:43], v[138:139], s[68:69] op_sel_hi:[1,0]
    v_pk_mul_f32 v[44:45], v[140:141], s[68:69] op_sel_hi:[1,0]
    v_pk_mul_f32 v[46:47], v[142:143], s[68:69] op_sel_hi:[1,0]
    v_mfma_f32_32x32x16_bf16 v[224:239], v[72:75], v[64:67], v[224:239]
    v_exp_f32_e64 v32, v32 clamp
    v_exp_f32_e64 v33, v33 clamp
    v_exp_f32_e64 v34, v34 clamp
    v_mfma_f32_32x32x16_bf16 v[224:239], v[76:79], v[68:71], v[224:239]
    v_exp_f32_e64 v35, v35 clamp
    v_exp_f32_e64 v36, v36 clamp
    v_exp_f32_e64 v37, v37 clamp
    v_mfma_f32_32x32x16_bf16 v[160:175], v[80:83], v[64:67], v[160:175]
    v_exp_f32_e64 v38, v38 clamp
    v_exp_f32_e64 v39, v39 clamp
    v_exp_f32_e64 v40, v40 clamp
    v_mfma_f32_32x32x16_bf16 v[160:175], v[80:83], v[68:71], v[160:175]
    v_exp_f32_e64 v41, v41 clamp
    v_exp_f32_e64 v42, v42 clamp
    v_exp_f32_e64 v43, v43 clamp
    v_exp_f32_e64 v44, v44 clamp
    v_exp_f32_e64 v45, v45 clamp
    v_exp_f32_e64 v46, v46 clamp
    v_exp_f32_e64 v47, v47 clamp
    v_max_f32 v128, s69, v128
    v_max_f32 v129, s69, v129
    v_max_f32 v130, s69, v130
    v_max_f32 v131, s69, v131
    v_max_f32 v132, s69, v132
    v_max_f32 v133, s69, v133
    v_max_f32 v134, s69, v134
    v_max_f32 v135, s69, v135
    v_max_f32 v136, s69, v136
    v_max_f32 v137, s69, v137
    v_max_f32 v138, s69, v138
    v_max_f32 v139, s69, v139
    v_max_f32 v140, s69, v140
    v_max_f32 v141, s69, v141
    v_max_f32 v142, s69, v142
    v_max_f32 v143, s69, v143
    v_cvt_pk_bf16_f32 v56, v192, v193
    v_cvt_pk_bf16_f32 v57, v194, v195
    v_cvt_pk_bf16_f32 v58, v196, v197
    v_cvt_pk_bf16_f32 v59, v198, v199
    v_cvt_pk_bf16_f32 v60, v200, v201
    v_cvt_pk_bf16_f32 v61, v202, v203
    v_cvt_pk_bf16_f32 v62, v204, v205
    v_cvt_pk_bf16_f32 v63, v206, v207
    v_pk_add_f32 v[128:129], v[128:129], v[32:33]
    v_pk_add_f32 v[130:131], v[130:131], v[34:35]
    v_pk_add_f32 v[132:133], v[132:133], v[36:37]
    v_pk_add_f32 v[134:135], v[134:135], v[38:39]
    v_pk_add_f32 v[136:137], v[136:137], v[40:41]
    v_pk_add_f32 v[138:139], v[138:139], v[42:43]
    v_pk_add_f32 v[140:141], v[140:141], v[44:45]
    v_pk_add_f32 v[142:143], v[142:143], v[46:47]
    v_cvt_pk_bf16_f32 v48, v128, v129
    v_cvt_pk_bf16_f32 v49, v130, v131
    v_cvt_pk_bf16_f32 v50, v132, v133
    v_cvt_pk_bf16_f32 v51, v134, v135
    v_cvt_pk_bf16_f32 v52, v136, v137
    v_cvt_pk_bf16_f32 v53, v138, v139
    v_cvt_pk_bf16_f32 v54, v140, v141
    v_cvt_pk_bf16_f32 v55, v142, v143
    v_pk_mul_f32 v[32:33], v[144:145], s[68:69] op_sel_hi:[1,0]
    v_pk_mul_f32 v[34:35], v[146:147], s[68:69] op_sel_hi:[1,0]
    v_pk_mul_f32 v[36:37], v[148:149], s[68:69] op_sel_hi:[1,0]
    v_pk_mul_f32 v[38:39], v[150:151], s[68:69] op_sel_hi:[1,0]
    v_pk_mul_f32 v[40:41], v[152:153], s[68:69] op_sel_hi:[1,0]
    v_pk_mul_f32 v[42:43], v[154:155], s[68:69] op_sel_hi:[1,0]
    v_pk_mul_f32 v[44:45], v[156:157], s[68:69] op_sel_hi:[1,0]
    v_pk_mul_f32 v[46:47], v[158:159], s[68:69] op_sel_hi:[1,0]
    v_mfma_f32_32x32x16_bf16 v[224:239], v[56:59], v[48:51], v[224:239]
    v_exp_f32_e64 v32, v32 clamp
    v_exp_f32_e64 v33, v33 clamp
    v_exp_f32_e64 v34, v34 clamp
    v_mfma_f32_32x32x16_bf16 v[224:239], v[60:63], v[52:55], v[224:239]
    v_exp_f32_e64 v35, v35 clamp
    v_exp_f32_e64 v36, v36 clamp
    v_exp_f32_e64 v37, v37 clamp
    v_mfma_f32_32x32x16_bf16 v[160:175], v[80:83], v[48:51], v[160:175]
    v_exp_f32_e64 v38, v38 clamp
    v_exp_f32_e64 v39, v39 clamp
    v_exp_f32_e64 v40, v40 clamp
    v_mfma_f32_32x32x16_bf16 v[160:175], v[80:83], v[52:55], v[160:175]
    v_exp_f32_e64 v41, v41 clamp
    v_exp_f32_e64 v42, v42 clamp
    v_exp_f32_e64 v43, v43 clamp
    v_exp_f32_e64 v44, v44 clamp
    v_exp_f32_e64 v45, v45 clamp
    v_exp_f32_e64 v46, v46 clamp
    v_exp_f32_e64 v47, v47 clamp
    v_max_f32 v144, s69, v144
    v_max_f32 v145, s69, v145
    v_max_f32 v146, s69, v146
    v_max_f32 v147, s69, v147
    v_max_f32 v148, s69, v148
    v_max_f32 v149, s69, v149
    v_max_f32 v150, s69, v150
    v_max_f32 v151, s69, v151
    v_max_f32 v152, s69, v152
    v_max_f32 v153, s69, v153
    v_max_f32 v154, s69, v154
    v_max_f32 v155, s69, v155
    v_max_f32 v156, s69, v156
    v_max_f32 v157, s69, v157
    v_max_f32 v158, s69, v158
    v_max_f32 v159, s69, v159
    v_cvt_pk_bf16_f32 v72, v208, v209
    v_cvt_pk_bf16_f32 v73, v210, v211
    v_cvt_pk_bf16_f32 v74, v212, v213
    v_cvt_pk_bf16_f32 v75, v214, v215
    v_cvt_pk_bf16_f32 v76, v216, v217
    v_cvt_pk_bf16_f32 v77, v218, v219
    v_cvt_pk_bf16_f32 v78, v220, v221
    v_cvt_pk_bf16_f32 v79, v222, v223
    v_pk_add_f32 v[144:145], v[144:145], v[32:33]
    v_pk_add_f32 v[146:147], v[146:147], v[34:35]
    v_pk_add_f32 v[148:149], v[148:149], v[36:37]
    v_pk_add_f32 v[150:151], v[150:151], v[38:39]
    v_pk_add_f32 v[152:153], v[152:153], v[40:41]
    v_pk_add_f32 v[154:155], v[154:155], v[42:43]
    v_pk_add_f32 v[156:157], v[156:157], v[44:45]
    v_pk_add_f32 v[158:159], v[158:159], v[46:47]
    v_cvt_pk_bf16_f32 v64, v144, v145
    v_cvt_pk_bf16_f32 v65, v146, v147
    v_cvt_pk_bf16_f32 v66, v148, v149
    v_cvt_pk_bf16_f32 v67, v150, v151
    v_cvt_pk_bf16_f32 v68, v152, v153
    v_cvt_pk_bf16_f32 v69, v154, v155
    v_cvt_pk_bf16_f32 v70, v156, v157
    v_cvt_pk_bf16_f32 v71, v158, v159
    s_nop 1
    v_mfma_f32_32x32x16_bf16 v[224:239], v[72:75], v[64:67], v[224:239]
    v_mfma_f32_32x32x16_bf16 v[224:239], v[76:79], v[68:71], v[224:239]
    v_mfma_f32_32x32x16_bf16 v[160:175], v[80:83], v[64:67], v[160:175]
    v_mfma_f32_32x32x16_bf16 v[160:175], v[80:83], v[68:71], v[160:175]
    s_nop 9
    s_mov_b64 exec, s[66:67]
    v_mov_b32 v224, v232
    v_mov_b32 v225, v233
    v_mov_b32 v226, v234
    v_mov_b32 v227, v235
    v_mov_b32 v228, v236
    v_mov_b32 v229, v237
    v_mov_b32 v230, v238
    v_mov_b32 v231, v239
    s_mov_b64 exec, -1
    buffer_atomic_add_f32 v224, v3, s[20:23], s64 offen offset:0
    buffer_atomic_add_f32 v225, v3, s[20:23], s64 offen offset:64
    buffer_atomic_add_f32 v226, v3, s[20:23], s64 offen offset:128
    buffer_atomic_add_f32 v227, v3, s[20:23], s64 offen offset:192
    buffer_atomic_add_f32 v228, v3, s[20:23], s64 offen offset:512
    buffer_atomic_add_f32 v229, v3, s[20:23], s64 offen offset:576
    buffer_atomic_add_f32 v230, v3, s[20:23], s64 offen offset:640
    buffer_atomic_add_f32 v231, v3, s[20:23], s64 offen offset:704
    s_mov_b64 exec, 0xffffffff
    buffer_atomic_add_f32 v160, v5, s[20:23], s65 offen
    s_mov_b64 exec, -1
K1_JOIN:
    v_lshrrev_b32 v3, 5, v1
    v_bfe_u32 v4, v1, 2, 2
    v_lshl_add_u32 v3, v3, 2, v4
    v_lshlrev_b32 v3, 7, v3
    v_bfe_u32 v4, v1, 3, 1
    v_lshl_add_u32 v3, v4, 6, v3
    v_bfe_u32 v4, v1, 4, 1
    v_lshl_add_u32 v3, v4, 5, v3
    v_and_b32 v4, 3, v1
    v_lshl_add_u32 v12, v4, 3, v3
    s_lshl_b32 s3, s42, 6
    v_xor_b32 v12, s3, v12
    s_mul_i32 s3, s42, 16384
    s_add_u32 s3, s3, 110592
    v_add_u32 v14, s3, v12
    v_xor_b32 v15, 64, v14
    s_mul_i32 s3, s42, 36864
    s_add_u32 s3, s3, 69632
    v_add_u32 v20, s3, v12
    v_xor_b32 v21, 64, v20
    s_mul_i32 s3, s42, 73728
    s_add_u32 s3, s3, 0
    v_add_u32 v24, s3, v12
    v_xor_b32 v25, 64, v24
    s_mul_i32 s3, s42, 8192
    s_add_u32 s3, s3, 147456
    v_add_u32 v28, s3, v12
    v_xor_b32 v29, 64, v28
    s_mul_i32 s3, s42, 18432
    s_add_u32 s3, s3, 32768
    v_add_u32 v12, s3, v12
    v_xor_b32 v13, 64, v12
K_lwg:
    ds_read_b32 v6, v27 offset:4
    s_waitcnt lgkmcnt(0)
    v_readfirstlane_b32 s66, v6
    s_cmp_lt_u32 s66, 4
    s_cbranch_scc1 K_lwg
    ds_read_b64_tr_b16 v[32:33], v14 offset:0
    ds_read_b64_tr_b16 v[34:35], v14 offset:1024
    ds_read_b64_tr_b16 v[36:37], v15 offset:0
    ds_read_b64_tr_b16 v[38:39], v15 offset:1024
    ds_read_b64_tr_b16 v[40:41], v14 offset:2048
    ds_read_b64_tr_b16 v[42:43], v14 offset:3072
    ds_read_b64_tr_b16 v[44:45], v15 offset:2048
    ds_read_b64_tr_b16 v[46:47], v15 offset:3072
    ds_read_b64_tr_b16 v[48:49], v14 offset:4096
    ds_read_b64_tr_b16 v[50:51], v14 offset:5120
    ds_read_b64_tr_b16 v[52:53], v15 offset:4096
    ds_read_b64_tr_b16 v[54:55], v15 offset:5120
    ds_read_b64_tr_b16 v[56:57], v14 offset:6144
    ds_read_b64_tr_b16 v[58:59], v14 offset:7168
    ds_read_b64_tr_b16 v[60:61], v15 offset:6144
    ds_read_b64_tr_b16 v[62:63], v15 offset:7168
    ds_read_b64_tr_b16 v[64:65], v14 offset:8192
    ds_read_b64_tr_b16 v[66:67], v14 offset:9216
    ds_read_b64_tr_b16 v[68:69], v15 offset:8192
    ds_read_b64_tr_b16 v[70:71], v15 offset:9216
    ds_read_b64_tr_b16 v[72:73], v14 offset:10240
    ds_read_b64_tr_b16 v[74:75], v14 offset:11264
    ds_read_b64_tr_b16 v[76:77], v15 offset:10240
    ds_read_b64_tr_b16 v[78:79], v15 offset:11264
    ds_read_b64_tr_b16 v[80:81], v14 offset:12288
    ds_read_b64_tr_b16 v[82:83], v14 offset:13312
    ds_read_b64_tr_b16 v[84:85], v15 offset:12288
    ds_read_b64_tr_b16 v[86:87], v15 offset:13312
    ds_read_b64_tr_b16 v[88:89], v14 offset:14336
    ds_read_b64_tr_b16 v[90:91], v14 offset:15360
    ds_read_b64_tr_b16 v[92:93], v15 offset:14336
    ds_read_b64_tr_b16 v[94:95], v15 offset:15360
    s_lshl4_add_u32 s64, s43, s44
    s_lshl_b32 s64, s64, 7
    s_add_u32 s64, s64, 8454144
    v_mov_b32 v7, 1
    v_and_b32 v3, 31, v1
    v_lshrrev_b32 v4, 5, v1
    v_lshlrev_b32 v11, 10, v3
    v_lshl_add_u32 v11, v4, 4, v11
    s_lshl_b32 s77, s74, 16
    s_lshl_b32 s3, s75, 7
    s_add_u32 s77, s77, s3
    s_lshl_b32 s3, s41, 15
    s_add_u32 s77, s77, s3
    s_lshl_b32 s3, s42, 6
    s_add_u32 s77, s77, s3
    s_mov_b32 s16, s92
    s_mov_b32 s17, s93
    s_mov_b32 s18, 2097152
    s_mov_b32 s19, 0x00020000
    s_lshl1_add_u32 s3, s74, s41
    s_mul_i32 s3, s3, 120832
    s_add_u32 s8, s38, s3
    s_addc_u32 s9, s39, 0
    s_mov_b32 s10, 88064
    s_mov_b32 s11, 0x00020000
    s_mul_i32 s79, s42, 43
    s_add_u32 s79, s79, s91
    s_sub_u32 s3, s79, 86
    s_cselect_b32 s79, s79, s3
    s_lshl_b32 s79, s79, 10
    s_lshl_b32 s65, s41, 12
    s_add_u32 s65, s65, 118784
    s_lshl_b32 s3, s42, 14
    s_add_u32 s66, s65, s3
    v_add_u32 v16, s66, v10
    s_xor_b32 s3, s3, 0x4000
    s_add_u32 s66, s65, s3
    v_add_u32 v17, s66, v10
    s_lshl_b32 s3, s41, 13
    s_lshl_b32 s65, s42, 12
    s_add_u32 s3, s3, s65
    v_add_u32 v18, s3, v10
    v_add_u32 v19, 73728, v18
    s_lshl_b32 s3, s40, 12
    s_add_u32 s3, s3, 147456
    v_add_u32 v18, s3, v10
    s_mov_b32 s68, 0xbfb8aa3b
    s_mov_b32 s70, 88064
    s_movk_i32 s71, 1024
    v_lshlrev_b32 v4, 7, v1
    s_mov_b32 s90, 0
    s_lshr_b32 s72, s74, 1
    s_lshl_b32 s72, s72, 11
    s_add_u32 s72, s72, 8454144
    s_waitcnt vmcnt(0)
    s_mov_b64 exec, 1
    ds_add_rtn_u32 v6, v27, v7
    s_waitcnt lgkmcnt(0)
    v_readfirstlane_b32 s66, v6
    s_cmp_eq_u32 s66, 3
    s_cbranch_scc0 K2_noflag
    buffer_store_dword v7, off, s[20:23], s64 sc0 sc1
K2_noflag:
    s_mov_b64 exec, -1
    s_barrier
    s_setprio 0
    v_lshrrev_b32 v5, 3, v0
    v_and_b32 v6, 7, v0
    v_lshlrev_b32 v182, 10, v5
    v_lshl_add_u32 v182, v6, 4, v182
    s_lshl_b32 s77, s74, 16
    s_lshl_b32 s3, s75, 7
    s_add_u32 s77, s77, s3
    s_mov_b32 s16, s92
    s_mov_b32 s17, s93
    s_mov_b32 s18, 2097152
    s_mov_b32 s19, 0x00020000
    buffer_load_dwordx4 v[184:187], v182, s[16:19], s77 offen
    s_mov_b32 s16, s86
    s_mov_b32 s17, s87
    s_mov_b32 s18, 2097152
    s_mov_b32 s19, 0x00020000
    s_mul_i32 s65, s42, 73728
    s_lshl_b32 s3, s41, 13
    s_add_u32 s65, s65, s3
    v_lshrrev_b32 v5, 3, v0
    v_and_b32 v6, 7, v0
    v_lshlrev_b32 v6, 1, v6
    v_and_b32 v8, 15, v5
    v_xor_b32 v6, v6, v8
    v_lshlrev_b32 v5, 8, v5
    v_lshl_add_u32 v176, v6, 4, v5
    v_xor_b32 v177, 16, v176
    v_add_u32 v178, 73728, v176
    v_add_u32 v179, 73728, v177
    v_add_u32 v180, 147456, v176
    v_add_u32 v181, 147456, v177
    v_and_b32 v5, 31, v1
    v_lshrrev_b32 v6, 5, v1
    v_lshl_add_u32 v6, s42, 3, v6
    v_and_b32 v8, 15, v1
    v_xor_b32 v6, v6, v8
    v_lshl_add_u32 v5, v5, 8, s65
    v_lshl_add_u32 v188, v6, 4, v5
    v_xor_b32 v189, 32, v188
    v_xor_b32 v190, 64, v188
    v_xor_b32 v191, 96, v188
    v_xor_b32 v192, 128, v188
    v_xor_b32 v193, 160, v188
    v_xor_b32 v194, 192, v188
    v_xor_b32 v195, 224, v188
    s_mov_b32 s68, 0xbfb8aa3b
    s_waitcnt vmcnt(0)
    v_lshlrev_b32 v168, 16, v184
    v_and_b32 v169, s54, v184
    v_lshlrev_b32 v170, 16, v185
    v_and_b32 v171, s54, v185
    v_lshlrev_b32 v172, 16, v186
    v_and_b32 v173, s54, v186
    v_lshlrev_b32 v174, 16, v187
    v_and_b32 v175, s54, v187
K_lwj:
    s_sleep 1
    ds_read_b32 v6, v27 offset:16
    s_waitcnt lgkmcnt(0)
    v_readfirstlane_b32 s66, v6
    s_cmp_lt_u32 s66, 1
    s_cbranch_scc1 K_lwj
    s_cmp_eq_u32 s66, 2
    s_cbranch_scc0 K2_ygo
    s_cmp_eq_u32 s40, 0
    s_cbranch_scc0 K2_ywait0
    s_mov_b64 exec, 0x3ff
    buffer_load_dword v5, v4, s[20:23], s72 offen sc0 sc1
    s_waitcnt vmcnt(0)
K2_poll:
    v_cmp_ne_u32 vcc, 0, v5
    s_cmp_eq_u32 vcc_lo, 0x3ff
    s_cbranch_scc1 K2_yset
    s_sleep 3
    buffer_load_dword v5, v4, s[20:23], s72 offen sc0 sc1
    s_add_u32 s90, s90, 1
    s_cmp_lt_u32 s90, 0x100000
    s_waitcnt vmcnt(0)
    s_cbranch_scc1 K2_poll
K2_yset:
    s_mov_b64 exec, 1
    ds_add_u32 v27, v7 offset:16
    s_mov_b64 exec, -1
    s_branch K2_ygo
K2_ywait0:
K_lwy:
    s_sleep 1
    ds_read_b32 v6, v27 offset:16
    s_waitcnt lgkmcnt(0)
    v_readfirstlane_b32 s66, v6
    s_cmp_lt_u32 s66, 3
    s_cbranch_scc1 K_lwy
K2_ygo:
    buffer_load_dwordx4 v[120:123], v10, s[8:11], s79 offen sc0 sc1
    s_add_u32 s79, s79, s71
    s_cmp_eq_u32 s79, s70
    s_cselect_b32 s79, 0, s79
    buffer_load_dwordx4 v[124:127], v10, s[8:11], s79 offen sc0 sc1
    s_add_u32 s79, s79, s71
    s_cmp_eq_u32 s79, s70
    s_cselect_b32 s79, 0, s79
    buffer_load_dwordx4 v[128:131], v10, s[8:11], s79 offen sc0 sc1
    s_add_u32 s79, s79, s71
    s_cmp_eq_u32 s79, s70
    s_cselect_b32 s79, 0, s79
    buffer_load_dwordx4 v[132:135], v10, s[8:11], s79 offen sc0 sc1
    s_add_u32 s79, s79, s71
    s_cmp_eq_u32 s79, s70
    s_cselect_b32 s79, 0, s79
    buffer_load_dwordx4 v[136:139], v10, s[8:11], s79 offen sc0 sc1
    s_add_u32 s79, s79, s71
    s_cmp_eq_u32 s79, s70
    s_cselect_b32 s79, 0, s79
    ds_read_b64_tr_b16 v[96:97], v12 offset:0
    ds_read_b64_tr_b16 v[98:99], v12 offset:1024
    ds_read_b64_tr_b16 v[100:101], v13 offset:0
    ds_read_b64_tr_b16 v[102:103], v13 offset:1024
    ds_read_b64_tr_b16 v[104:105], v12 offset:2048
    ds_read_b64_tr_b16 v[106:107], v12 offset:3072
    ds_read_b64_tr_b16 v[108:109], v13 offset:2048
    ds_read_b64_tr_b16 v[110:111], v13 offset:3072
    ds_read_b64_tr_b16 v[112:113], v12 offset:4096
    ds_read_b64_tr_b16 v[114:115], v12 offset:5120
    ds_read_b64_tr_b16 v[116:117], v13 offset:4096
    ds_read_b64_tr_b16 v[118:119], v13 offset:5120
    buffer_load_dwordx4 v[140:143], v10, s[8:11], s79 offen sc0 sc1
    s_add_u32 s79, s79, s71
    s_cmp_eq_u32 s79, s70
    s_cselect_b32 s79, 0, s79
    s_waitcnt vmcnt(5)
    v_mfma_f32_32x32x16_bf16 v[216:231], v[36:39], v[120:123], 0
    buffer_load_dwordx4 v[144:147], v10, s[8:11], s79 offen sc0 sc1
    s_add_u32 s79, s79, s71
    s_cmp_eq_u32 s79, s70
    s_cselect_b32 s79, 0, s79
    v_mfma_f32_32x32x16_bf16 v[200:215], v[32:35], v[120:123], 0
    ds_read_b64_tr_b16 v[32:33], v12 offset:6144
    ds_read_b64_tr_b16 v[34:35], v12 offset:7168
    ds_read_b64_tr_b16 v[36:37], v13 offset:6144
    ds_read_b64_tr_b16 v[38:39], v13 offset:7168
    s_waitcnt vmcnt(5)
    v_mfma_f32_32x32x16_bf16 v[216:231], v[44:47], v[124:127], v[216:231]
    buffer_load_dwordx4 v[148:151], v10, s[8:11], s79 offen sc0 sc1
    s_add_u32 s79, s79, s71
    s_cmp_eq_u32 s79, s70
    s_cselect_b32 s79, 0, s79
    v_mfma_f32_32x32x16_bf16 v[200:215], v[40:43], v[124:127], v[200:215]
    ds_read_b64_tr_b16 v[40:41], v12 offset:8192
    ds_read_b64_tr_b16 v[42:43], v12 offset:9216
    ds_read_b64_tr_b16 v[44:45], v13 offset:8192
    ds_read_b64_tr_b16 v[46:47], v13 offset:9216
    s_waitcnt vmcnt(5)
    v_mfma_f32_32x32x16_bf16 v[216:231], v[52:55], v[128:131], v[216:231]
    buffer_load_dwordx4 v[152:155], v10, s[8:11], s79 offen sc0 sc1
    s_add_u32 s79, s79, s71
    s_cmp_eq_u32 s79, s70
    s_cselect_b32 s79, 0, s79
    v_mfma_f32_32x32x16_bf16 v[200:215], v[48:51], v[128:131], v[200:215]
    ds_read_b64_tr_b16 v[48:49], v12 offset:10240
    ds_read_b64_tr_b16 v[50:51], v12 offset:11264
    ds_read_b64_tr_b16 v[52:53], v13 offset:10240
    ds_read_b64_tr_b16 v[54:55], v13 offset:11264
    s_waitcnt vmcnt(5)
    v_mfma_f32_32x32x16_bf16 v[216:231], v[60:63], v[132:135], v[216:231]
    buffer_load_dwordx4 v[156:159], v10, s[8:11], s79 offen sc0 sc1
    s_add_u32 s79, s79, s71
    s_cmp_eq_u32 s79, s70
    s_cselect_b32 s79, 0, s79
    v_mfma_f32_32x32x16_bf16 v[200:215], v[56:59], v[132:135], v[200:215]
    ds_read_b64_tr_b16 v[56:57], v12 offset:12288
    ds_read_b64_tr_b16 v[58:59], v12 offset:13312
    ds_read_b64_tr_b16 v[60:61], v13 offset:12288
    ds_read_b64_tr_b16 v[62:63], v13 offset:13312
    s_waitcnt vmcnt(5)
    v_mfma_f32_32x32x16_bf16 v[216:231], v[68:71], v[136:139], v[216:231]
    buffer_load_dwordx4 v[160:163], v10, s[8:11], s79 offen sc0 sc1
    s_add_u32 s79, s79, s71
    s_cmp_eq_u32 s79, s70
    s_cselect_b32 s79, 0, s79
    v_mfma_f32_32x32x16_bf16 v[200:215], v[64:67], v[136:139], v[200:215]
    ds_read_b64_tr_b16 v[64:65], v12 offset:14336
    ds_read_b64_tr_b16 v[66:67], v12 offset:15360
    ds_read_b64_tr_b16 v[68:69], v13 offset:14336
    ds_read_b64_tr_b16 v[70:71], v13 offset:15360
    s_waitcnt vmcnt(5)
    v_mfma_f32_32x32x16_bf16 v[216:231], v[76:79], v[140:143], v[216:231]
    buffer_load_dwordx4 v[164:167], v10, s[8:11], s79 offen sc0 sc1
    s_add_u32 s79, s79, s71
    s_cmp_eq_u32 s79, s70
    s_cselect_b32 s79, 0, s79
    v_mfma_f32_32x32x16_bf16 v[200:215], v[72:75], v[140:143], v[200:215]
    ds_read_b64_tr_b16 v[72:73], v12 offset:16384
    ds_read_b64_tr_b16 v[74:75], v12 offset:17408
    ds_read_b64_tr_b16 v[76:77], v13 offset:16384
    ds_read_b64_tr_b16 v[78:79], v13 offset:17408
    s_waitcnt vmcnt(5)
    v_mfma_f32_32x32x16_bf16 v[216:231], v[84:87], v[144:147], v[216:231]
    buffer_load_dwordx4 v[120:123], v10, s[8:11], s79 offen sc0 sc1
    s_add_u32 s79, s79, s71
    s_cmp_eq_u32 s79, s70
    s_cselect_b32 s79, 0, s79
    v_mfma_f32_32x32x16_bf16 v[200:215], v[80:83], v[144:147], v[200:215]
    ds_read_b64_tr_b16 v[80:81], v20 offset:0
    ds_read_b64_tr_b16 v[82:83], v20 offset:1024
    ds_read_b64_tr_b16 v[84:85], v21 offset:0
    ds_read_b64_tr_b16 v[86:87], v21 offset:1024
    s_waitcnt vmcnt(5)
    v_mfma_f32_32x32x16_bf16 v[216:231], v[92:95], v[148:151], v[216:231]
    buffer_load_dwordx4 v[124:127], v10, s[8:11], s79 offen sc0 sc1
    s_add_u32 s79, s79, s71
    s_cmp_eq_u32 s79, s70
    s_cselect_b32 s79, 0, s79
    v_mfma_f32_32x32x16_bf16 v[200:215], v[88:91], v[148:151], v[200:215]
    ds_read_b64_tr_b16 v[88:89], v20 offset:2048
    ds_read_b64_tr_b16 v[90:91], v20 offset:3072
    ds_read_b64_tr_b16 v[92:93], v21 offset:2048
    ds_read_b64_tr_b16 v[94:95], v21 offset:3072
    s_waitcnt vmcnt(5) lgkmcnt(12)
    v_mfma_f32_32x32x16_bf16 v[216:231], v[100:103], v[152:155], v[216:231]
    buffer_load_dwordx4 v[128:131], v10, s[8:11], s79 offen sc0 sc1
    s_add_u32 s79, s79, s71
    s_cmp_eq_u32 s79, s70
    s_cselect_b32 s79, 0, s79
    v_mfma_f32_32x32x16_bf16 v[200:215], v[96:99], v[152:155], v[200:215]
    ds_read_b64_tr_b16 v[96:97], v28 offset:0
    ds_read_b64_tr_b16 v[98:99], v28 offset:1024
    ds_read_b64_tr_b16 v[100:101], v29 offset:0
    ds_read_b64_tr_b16 v[102:103], v29 offset:1024
    s_waitcnt vmcnt(5) lgkmcnt(12)
    v_mfma_f32_32x32x16_bf16 v[216:231], v[108:111], v[156:159], v[216:231]
    buffer_load_dwordx4 v[132:135], v10, s[8:11], s79 offen sc0 sc1
    s_add_u32 s79, s79, s71
    s_cmp_eq_u32 s79, s70
    s_cselect_b32 s79, 0, s79
    v_mfma_f32_32x32x16_bf16 v[200:215], v[104:107], v[156:159], v[200:215]
    ds_read_b64_tr_b16 v[104:105], v28 offset:2048
    ds_read_b64_tr_b16 v[106:107], v28 offset:3072
    ds_read_b64_tr_b16 v[108:109], v29 offset:2048
    ds_read_b64_tr_b16 v[110:111], v29 offset:3072
    s_waitcnt vmcnt(5) lgkmcnt(12)
    v_mfma_f32_32x32x16_bf16 v[216:231], v[116:119], v[160:163], v[216:231]
    buffer_load_dwordx4 v[136:139], v10, s[8:11], s79 offen sc0 sc1
    s_add_u32 s79, s79, s71
    s_cmp_eq_u32 s79, s70
    s_cselect_b32 s79, 0, s79
    v_mfma_f32_32x32x16_bf16 v[200:215], v[112:115], v[160:163], v[200:215]
    ds_read_b64_tr_b16 v[112:113], v28 offset:4096
    ds_read_b64_tr_b16 v[114:115], v28 offset:5120
    ds_read_b64_tr_b16 v[116:117], v29 offset:4096
    ds_read_b64_tr_b16 v[118:119], v29 offset:5120
    s_waitcnt vmcnt(5) lgkmcnt(12)
    v_mfma_f32_32x32x16_bf16 v[216:231], v[36:39], v[164:167], v[216:231]
    buffer_load_dwordx4 v[140:143], v10, s[8:11], s79 offen sc0 sc1
    s_add_u32 s79, s79, s71
    s_cmp_eq_u32 s79, s70
    s_cselect_b32 s79, 0, s79
    v_mfma_f32_32x32x16_bf16 v[200:215], v[32:35], v[164:167], v[200:215]
    ds_read_b64_tr_b16 v[32:33], v28 offset:6144
    ds_read_b64_tr_b16 v[34:35], v28 offset:7168
    ds_read_b64_tr_b16 v[36:37], v29 offset:6144
    ds_read_b64_tr_b16 v[38:39], v29 offset:7168
    s_waitcnt vmcnt(5) lgkmcnt(12)
    v_mfma_f32_32x32x16_bf16 v[216:231], v[44:47], v[120:123], v[216:231]
    buffer_load_dwordx4 v[144:147], v10, s[8:11], s79 offen sc0 sc1
    s_add_u32 s79, s79, s71
    s_cmp_eq_u32 s79, s70
    s_cselect_b32 s79, 0, s79
    v_mfma_f32_32x32x16_bf16 v[200:215], v[40:43], v[120:123], v[200:215]
K_lwr:
    ds_read_b32 v6, v27 offset:12
    s_waitcnt lgkmcnt(0)
    v_readfirstlane_b32 s66, v6
    s_cmp_lt_u32 s66, 4
    s_cbranch_scc1 K_lwr
    ds_read_b64_tr_b16 v[40:41], v24 offset:0
    ds_read_b64_tr_b16 v[42:43], v24 offset:1024
    ds_read_b64_tr_b16 v[44:45], v25 offset:0
    ds_read_b64_tr_b16 v[46:47], v25 offset:1024
    s_waitcnt vmcnt(5) lgkmcnt(12)
    v_mfma_f32_32x32x16_bf16 v[216:231], v[52:55], v[124:127], v[216:231]
    buffer_load_dwordx4 v[148:151], v10, s[8:11], s79 offen sc0 sc1
    s_add_u32 s79, s79, s71
    s_cmp_eq_u32 s79, s70
    s_cselect_b32 s79, 0, s79
    v_mfma_f32_32x32x16_bf16 v[200:215], v[48:51], v[124:127], v[200:215]
    ds_read_b64_tr_b16 v[48:49], v24 offset:2048
    ds_read_b64_tr_b16 v[50:51], v24 offset:3072
    ds_read_b64_tr_b16 v[52:53], v25 offset:2048
    ds_read_b64_tr_b16 v[54:55], v25 offset:3072
    s_waitcnt vmcnt(5) lgkmcnt(12)
    v_mfma_f32_32x32x16_bf16 v[216:231], v[60:63], v[128:131], v[216:231]
    buffer_load_dwordx4 v[152:155], v10, s[8:11], s79 offen sc0 sc1
    s_add_u32 s79, s79, s71
    s_cmp_eq_u32 s79, s70
    s_cselect_b32 s79, 0, s79
    v_mfma_f32_32x32x16_bf16 v[200:215], v[56:59], v[128:131], v[200:215]
    ds_read_b64_tr_b16 v[56:57], v24 offset:4096
    ds_read_b64_tr_b16 v[58:59], v24 offset:5120
    ds_read_b64_tr_b16 v[60:61], v25 offset:4096
    ds_read_b64_tr_b16 v[62:63], v25 offset:5120
    s_waitcnt vmcnt(5) lgkmcnt(12)
    v_mfma_f32_32x32x16_bf16 v[216:231], v[68:71], v[132:135], v[216:231]
    buffer_load_dwordx4 v[156:159], v10, s[8:11], s79 offen sc0 sc1
    s_add_u32 s79, s79, s71
    s_cmp_eq_u32 s79, s70
    s_cselect_b32 s79, 0, s79
    v_mfma_f32_32x32x16_bf16 v[200:215], v[64:67], v[132:135], v[200:215]
    ds_read_b64_tr_b16 v[64:65], v24 offset:6144
    ds_read_b64_tr_b16 v[66:67], v24 offset:7168
    ds_read_b64_tr_b16 v[68:69], v25 offset:6144
    ds_read_b64_tr_b16 v[70:71], v25 offset:7168
    s_waitcnt vmcnt(5) lgkmcnt(12)
    v_mfma_f32_32x32x16_bf16 v[216:231], v[76:79], v[136:139], v[216:231]
    buffer_load_dwordx4 v[160:163], v10, s[8:11], s79 offen sc0 sc1
    s_add_u32 s79, s79, s71
    s_cmp_eq_u32 s79, s70
    s_cselect_b32 s79, 0, s79
    v_mfma_f32_32x32x16_bf16 v[200:215], v[72:75], v[136:139], v[200:215]
    ds_read_b64_tr_b16 v[72:73], v24 offset:8192
    ds_read_b64_tr_b16 v[74:75], v24 offset:9216
    ds_read_b64_tr_b16 v[76:77], v25 offset:8192
    ds_read_b64_tr_b16 v[78:79], v25 offset:9216
    s_waitcnt vmcnt(5) lgkmcnt(12)
    v_mfma_f32_32x32x16_bf16 v[216:231], v[84:87], v[140:143], v[216:231]
    buffer_load_dwordx4 v[164:167], v10, s[8:11], s79 offen sc0 sc1
    s_add_u32 s79, s79, s71
    s_cmp_eq_u32 s79, s70
    s_cselect_b32 s79, 0, s79
    v_mfma_f32_32x32x16_bf16 v[200:215], v[80:83], v[140:143], v[200:215]
    ds_read_b64_tr_b16 v[80:81], v24 offset:10240
    ds_read_b64_tr_b16 v[82:83], v24 offset:11264
    ds_read_b64_tr_b16 v[84:85], v25 offset:10240
    ds_read_b64_tr_b16 v[86:87], v25 offset:11264
    s_waitcnt vmcnt(5) lgkmcnt(12)
    v_mfma_f32_32x32x16_bf16 v[216:231], v[92:95], v[144:147], v[216:231]
    buffer_load_dwordx4 v[120:123], v10, s[8:11], s79 offen sc0 sc1
    s_add_u32 s79, s79, s71
    s_cmp_eq_u32 s79, s70
    s_cselect_b32 s79, 0, s79
    v_mfma_f32_32x32x16_bf16 v[200:215], v[88:91], v[144:147], v[200:215]
    ds_read_b64_tr_b16 v[88:89], v24 offset:12288
    ds_read_b64_tr_b16 v[90:91], v24 offset:13312
    ds_read_b64_tr_b16 v[92:93], v25 offset:12288
    ds_read_b64_tr_b16 v[94:95], v25 offset:13312
    s_waitcnt vmcnt(5) lgkmcnt(12)
    v_mfma_f32_32x32x16_bf16 v[216:231], v[100:103], v[148:151], v[216:231]
    buffer_load_dwordx4 v[124:127], v10, s[8:11], s79 offen sc0 sc1
    s_add_u32 s79, s79, s71
    s_cmp_eq_u32 s79, s70
    s_cselect_b32 s79, 0, s79
    v_mfma_f32_32x32x16_bf16 v[200:215], v[96:99], v[148:151], v[200:215]
    ds_read_b64_tr_b16 v[96:97], v24 offset:14336
    ds_read_b64_tr_b16 v[98:99], v24 offset:15360
    ds_read_b64_tr_b16 v[100:101], v25 offset:14336
    ds_read_b64_tr_b16 v[102:103], v25 offset:15360
    s_waitcnt vmcnt(5) lgkmcnt(12)
    v_mfma_f32_32x32x16_bf16 v[216:231], v[108:111], v[152:155], v[216:231]
    buffer_load_dwordx4 v[128:131], v10, s[8:11], s79 offen sc0 sc1
    s_add_u32 s79, s79, s71
    s_cmp_eq_u32 s79, s70
    s_cselect_b32 s79, 0, s79
    v_mfma_f32_32x32x16_bf16 v[200:215], v[104:107], v[152:155], v[200:215]
    s_waitcnt lgkmcnt(0)
    s_barrier
    s_waitcnt vmcnt(5)
    v_mfma_f32_32x32x16_bf16 v[216:231], v[116:119], v[156:159], v[216:231]
    buffer_load_dwordx4 v[132:135], v10, s[8:11], s79 offen sc0 sc1
    s_add_u32 s79, s79, s71
    s_cmp_eq_u32 s79, s70
    s_cselect_b32 s79, 0, s79
    v_mfma_f32_32x32x16_bf16 v[200:215], v[112:115], v[156:159], v[200:215]
    s_waitcnt vmcnt(5)
    v_mfma_f32_32x32x16_bf16 v[216:231], v[36:39], v[160:163], v[216:231]
    buffer_load_dwordx4 v[136:139], v10, s[8:11], s79 offen sc0 sc1
    s_add_u32 s79, s79, s71
    s_cmp_eq_u32 s79, s70
    s_cselect_b32 s79, 0, s79
    v_mfma_f32_32x32x16_bf16 v[200:215], v[32:35], v[160:163], v[200:215]
    s_waitcnt vmcnt(5)
    v_mfma_f32_32x32x16_bf16 v[216:231], v[44:47], v[164:167], v[216:231]
    buffer_load_dwordx4 v[140:143], v10, s[8:11], s79 offen sc0 sc1
    s_add_u32 s79, s79, s71
    s_cmp_eq_u32 s79, s70
    s_cselect_b32 s79, 0, s79
    v_mfma_f32_32x32x16_bf16 v[200:215], v[40:43], v[164:167], v[200:215]
    s_waitcnt vmcnt(5)
    v_mfma_f32_32x32x16_bf16 v[216:231], v[52:55], v[120:123], v[216:231]
    buffer_load_dwordx4 v[144:147], v10, s[8:11], s79 offen sc0 sc1
    s_add_u32 s79, s79, s71
    s_cmp_eq_u32 s79, s70
    s_cselect_b32 s79, 0, s79
    v_mfma_f32_32x32x16_bf16 v[200:215], v[48:51], v[120:123], v[200:215]
    s_waitcnt vmcnt(5)
    v_mfma_f32_32x32x16_bf16 v[216:231], v[60:63], v[124:127], v[216:231]
    buffer_load_dwordx4 v[148:151], v10, s[8:11], s79 offen sc0 sc1
    s_add_u32 s79, s79, s71
    s_cmp_eq_u32 s79, s70
    s_cselect_b32 s79, 0, s79
    v_mfma_f32_32x32x16_bf16 v[200:215], v[56:59], v[124:127], v[200:215]
    s_waitcnt vmcnt(5)
    v_mfma_f32_32x32x16_bf16 v[216:231], v[68:71], v[128:131], v[216:231]
    buffer_load_dwordx4 v[152:155], v10, s[8:11], s79 offen sc0 sc1
    s_add_u32 s79, s79, s71
    s_cmp_eq_u32 s79, s70
    s_cselect_b32 s79, 0, s79
    v_mfma_f32_32x32x16_bf16 v[200:215], v[64:67], v[128:131], v[200:215]
    s_waitcnt vmcnt(5)
    v_mfma_f32_32x32x16_bf16 v[216:231], v[76:79], v[132:135], v[216:231]
    buffer_load_dwordx4 v[156:159], v10, s[8:11], s79 offen sc0 sc1
    s_add_u32 s79, s79, s71
    s_cmp_eq_u32 s79, s70
    s_cselect_b32 s79, 0, s79
    v_mfma_f32_32x32x16_bf16 v[200:215], v[72:75], v[132:135], v[200:215]
    s_waitcnt vmcnt(5)
    v_mfma_f32_32x32x16_bf16 v[216:231], v[84:87], v[136:139], v[216:231]
    buffer_load_dwordx4 v[160:163], v10, s[8:11], s79 offen sc0 sc1
    s_add_u32 s79, s79, s71
    s_cmp_eq_u32 s79, s70
    s_cselect_b32 s79, 0, s79
    v_mfma_f32_32x32x16_bf16 v[200:215], v[80:83], v[136:139], v[200:215]
    ds_read_b64_tr_b16 v[104:105], v24 offset:16384
    ds_read_b64_tr_b16 v[106:107], v24 offset:17408
    ds_read_b64_tr_b16 v[108:109], v25 offset:16384
    ds_read_b64_tr_b16 v[110:111], v25 offset:17408
    s_waitcnt vmcnt(5)
    v_mfma_f32_32x32x16_bf16 v[216:231], v[92:95], v[140:143], v[216:231]
    buffer_load_dwordx4 v[164:167], v10, s[8:11], s79 offen sc0 sc1
    s_add_u32 s79, s79, s71
    s_cmp_eq_u32 s79, s70
    s_cselect_b32 s79, 0, s79
    v_mfma_f32_32x32x16_bf16 v[200:215], v[88:91], v[140:143], v[200:215]
    ds_read_b64_tr_b16 v[112:113], v24 offset:18432
    ds_read_b64_tr_b16 v[114:115], v24 offset:19456
    ds_read_b64_tr_b16 v[116:117], v25 offset:18432
    ds_read_b64_tr_b16 v[118:119], v25 offset:19456
    s_waitcnt vmcnt(5)
    v_mfma_f32_32x32x16_bf16 v[216:231], v[100:103], v[144:147], v[216:231]
    buffer_load_dwordx4 v[120:123], v10, s[8:11], s79 offen sc0 sc1
    s_add_u32 s79, s79, s71
    s_cmp_eq_u32 s79, s70
    s_cselect_b32 s79, 0, s79
    v_mfma_f32_32x32x16_bf16 v[200:215], v[96:99], v[144:147], v[200:215]
    ds_read_b64_tr_b16 v[32:33], v24 offset:20480
    ds_read_b64_tr_b16 v[34:35], v24 offset:21504
    ds_read_b64_tr_b16 v[36:37], v25 offset:20480
    ds_read_b64_tr_b16 v[38:39], v25 offset:21504
    s_waitcnt vmcnt(5) lgkmcnt(8)
    v_mfma_f32_32x32x16_bf16 v[216:231], v[108:111], v[148:151], v[216:231]
    buffer_load_dwordx4 v[124:127], v10, s[8:11], s79 offen sc0 sc1
    s_add_u32 s79, s79, s71
    s_cmp_eq_u32 s79, s70
    s_cselect_b32 s79, 0, s79
    v_mfma_f32_32x32x16_bf16 v[200:215], v[104:107], v[148:151], v[200:215]
    ds_read_b64_tr_b16 v[104:105], v24 offset:22528
    ds_read_b64_tr_b16 v[106:107], v24 offset:23552
    ds_read_b64_tr_b16 v[108:109], v25 offset:22528
    ds_read_b64_tr_b16 v[110:111], v25 offset:23552
    s_waitcnt vmcnt(5) lgkmcnt(8)
    v_mfma_f32_32x32x16_bf16 v[216:231], v[116:119], v[152:155], v[216:231]
    buffer_load_dwordx4 v[128:131], v10, s[8:11], s79 offen sc0 sc1
    s_add_u32 s79, s79, s71
    s_cmp_eq_u32 s79, s70
    s_cselect_b32 s79, 0, s79
    v_mfma_f32_32x32x16_bf16 v[200:215], v[112:115], v[152:155], v[200:215]
    ds_read_b64_tr_b16 v[112:113], v24 offset:24576
    ds_read_b64_tr_b16 v[114:115], v24 offset:25600
    ds_read_b64_tr_b16 v[116:117], v25 offset:24576
    ds_read_b64_tr_b16 v[118:119], v25 offset:25600
    s_waitcnt vmcnt(5) lgkmcnt(8)
    v_mfma_f32_32x32x16_bf16 v[216:231], v[36:39], v[156:159], v[216:231]
    buffer_load_dwordx4 v[132:135], v10, s[8:11], s79 offen sc0 sc1
    s_add_u32 s79, s79, s71
    s_cmp_eq_u32 s79, s70
    s_cselect_b32 s79, 0, s79
    v_mfma_f32_32x32x16_bf16 v[200:215], v[32:35], v[156:159], v[200:215]
    ds_read_b64_tr_b16 v[32:33], v24 offset:26624
    ds_read_b64_tr_b16 v[34:35], v24 offset:27648
    ds_read_b64_tr_b16 v[36:37], v25 offset:26624
    ds_read_b64_tr_b16 v[38:39], v25 offset:27648
    s_waitcnt vmcnt(5) lgkmcnt(8)
    v_mfma_f32_32x32x16_bf16 v[216:231], v[108:111], v[160:163], v[216:231]
    buffer_load_dwordx4 v[136:139], v10, s[8:11], s79 offen sc0 sc1
    s_add_u32 s79, s79, s71
    s_cmp_eq_u32 s79, s70
    s_cselect_b32 s79, 0, s79
    v_mfma_f32_32x32x16_bf16 v[200:215], v[104:107], v[160:163], v[200:215]
    ds_read_b64_tr_b16 v[104:105], v24 offset:28672
    ds_read_b64_tr_b16 v[106:107], v24 offset:29696
    ds_read_b64_tr_b16 v[108:109], v25 offset:28672
    ds_read_b64_tr_b16 v[110:111], v25 offset:29696
    s_waitcnt vmcnt(5) lgkmcnt(8)
    v_mfma_f32_32x32x16_bf16 v[216:231], v[116:119], v[164:167], v[216:231]
    buffer_load_dwordx4 v[140:143], v10, s[8:11], s79 offen sc0 sc1
    s_add_u32 s79, s79, s71
    s_cmp_eq_u32 s79, s70
    s_cselect_b32 s79, 0, s79
    v_mfma_f32_32x32x16_bf16 v[200:215], v[112:115], v[164:167], v[200:215]
    ds_read_b64_tr_b16 v[112:113], v24 offset:30720
    ds_read_b64_tr_b16 v[114:115], v24 offset:31744
    ds_read_b64_tr_b16 v[116:117], v25 offset:30720
    ds_read_b64_tr_b16 v[118:119], v25 offset:31744
    s_waitcnt vmcnt(5) lgkmcnt(8)
    v_mfma_f32_32x32x16_bf16 v[216:231], v[36:39], v[120:123], v[216:231]
    buffer_load_dwordx4 v[144:147], v10, s[8:11], s79 offen sc0 sc1
    v_mfma_f32_32x32x16_bf16 v[200:215], v[32:35], v[120:123], v[200:215]
    ds_read_b64_tr_b16 v[32:33], v14 offset:0
    ds_read_b64_tr_b16 v[34:35], v14 offset:1024
    ds_read_b64_tr_b16 v[36:37], v15 offset:0
    ds_read_b64_tr_b16 v[38:39], v15 offset:1024
    s_waitcnt vmcnt(5) lgkmcnt(8)
    v_mfma_f32_32x32x16_bf16 v[216:231], v[108:111], v[124:127], v[216:231]
    v_mfma_f32_32x32x16_bf16 v[200:215], v[104:107], v[124:127], v[200:215]
    ds_read_b64_tr_b16 v[104:105], v14 offset:2048
    ds_read_b64_tr_b16 v[106:107], v14 offset:3072
    ds_read_b64_tr_b16 v[108:109], v15 offset:2048
    ds_read_b64_tr_b16 v[110:111], v15 offset:3072
    s_waitcnt vmcnt(4) lgkmcnt(8)
    v_mfma_f32_32x32x16_bf16 v[216:231], v[116:119], v[128:131], v[216:231]
    v_mfma_f32_32x32x16_bf16 v[200:215], v[112:115], v[128:131], v[200:215]
    ds_read_b64_tr_b16 v[112:113], v14 offset:4096
    ds_read_b64_tr_b16 v[114:115], v14 offset:5120
    ds_read_b64_tr_b16 v[116:117], v15 offset:4096
    ds_read_b64_tr_b16 v[118:119], v15 offset:5120
    s_waitcnt vmcnt(3) lgkmcnt(8)
    v_mfma_f32_32x32x16_bf16 v[216:231], v[36:39], v[132:135], v[216:231]
    v_mfma_f32_32x32x16_bf16 v[200:215], v[32:35], v[132:135], v[200:215]
    ds_read_b64_tr_b16 v[32:33], v14 offset:6144
    ds_read_b64_tr_b16 v[34:35], v14 offset:7168
    ds_read_b64_tr_b16 v[36:37], v15 offset:6144
    ds_read_b64_tr_b16 v[38:39], v15 offset:7168
    s_waitcnt vmcnt(2) lgkmcnt(8)
    v_mfma_f32_32x32x16_bf16 v[216:231], v[108:111], v[136:139], v[216:231]
    v_mfma_f32_32x32x16_bf16 v[200:215], v[104:107], v[136:139], v[200:215]
    s_waitcnt vmcnt(1) lgkmcnt(4)
    v_mfma_f32_32x32x16_bf16 v[216:231], v[116:119], v[140:143], v[216:231]
    v_mfma_f32_32x32x16_bf16 v[200:215], v[112:115], v[140:143], v[200:215]
    s_waitcnt vmcnt(0) lgkmcnt(0)
    v_mfma_f32_32x32x16_bf16 v[216:231], v[36:39], v[144:147], v[216:231]
    v_mfma_f32_32x32x16_bf16 v[200:215], v[32:35], v[144:147], v[200:215]
    s_nop 10
    ds_write_b128 v192, v[216:219]
    ds_write_b128 v193, v[220:223]
    ds_write_b128 v194, v[224:227]
    ds_write_b128 v195, v[228:231]
    ds_write_b128 v188, v[200:203]
    ds_write_b128 v189, v[204:207]
    ds_write_b128 v190, v[208:211]
    ds_write_b128 v191, v[212:215]
K2_FIN8:
    s_waitcnt lgkmcnt(0)
    s_barrier
    ds_read_b128 v[32:35], v176
    ds_read_b128 v[36:39], v177
    ds_read_b128 v[40:43], v178
    ds_read_b128 v[44:47], v179
    ds_read_b128 v[48:51], v180
    ds_read_b128 v[52:55], v181
    s_waitcnt lgkmcnt(2)
    v_pk_add_f32 v[32:33], v[32:33], v[40:41]
    v_pk_add_f32 v[34:35], v[34:35], v[42:43]
    v_pk_add_f32 v[36:37], v[36:37], v[44:45]
    v_pk_add_f32 v[38:39], v[38:39], v[46:47]
    v_pk_mul_f32 v[40:41], v[32:33], s[68:69] op_sel_hi:[1,0]
    v_pk_mul_f32 v[42:43], v[34:35], s[68:69] op_sel_hi:[1,0]
    v_pk_mul_f32 v[44:45], v[36:37], s[68:69] op_sel_hi:[1,0]
    v_pk_mul_f32 v[46:47], v[38:39], s[68:69] op_sel_hi:[1,0]
    v_exp_f32 v40, v40
    v_exp_f32 v41, v41
    v_exp_f32 v42, v42
    v_exp_f32 v43, v43
    v_exp_f32 v44, v44
    v_exp_f32 v45, v45
    v_exp_f32 v46, v46
    v_exp_f32 v47, v47
    s_waitcnt lgkmcnt(0)
    v_pk_mul_f32 v[32:33], v[32:33], v[48:49]
    v_pk_mul_f32 v[34:35], v[34:35], v[50:51]
    v_pk_mul_f32 v[36:37], v[36:37], v[52:53]
    v_pk_mul_f32 v[38:39], v[38:39], v[54:55]
    v_pk_add_f32 v[40:41], v[40:41], 1.0 op_sel_hi:[1,0]
    v_pk_add_f32 v[42:43], v[42:43], 1.0 op_sel_hi:[1,0]
    v_pk_add_f32 v[44:45], v[44:45], 1.0 op_sel_hi:[1,0]
    v_pk_add_f32 v[46:47], v[46:47], 1.0 op_sel_hi:[1,0]
    v_rcp_f32 v40, v40
    v_rcp_f32 v41, v41
    v_rcp_f32 v42, v42
    v_rcp_f32 v43, v43
    v_rcp_f32 v44, v44
    v_rcp_f32 v45, v45
    v_rcp_f32 v46, v46
    v_rcp_f32 v47, v47
    v_pk_fma_f32 v[32:33], v[32:33], v[40:41], v[168:169]
    v_pk_fma_f32 v[34:35], v[34:35], v[42:43], v[170:171]
    v_pk_fma_f32 v[36:37], v[36:37], v[44:45], v[172:173]
    v_pk_fma_f32 v[38:39], v[38:39], v[46:47], v[174:175]
    v_cvt_pk_bf16_f32 v56, v32, v33
    v_cvt_pk_bf16_f32 v57, v34, v35
    v_cvt_pk_bf16_f32 v58, v36, v37
    v_cvt_pk_bf16_f32 v59, v38, v39
    buffer_store_dwordx4 v[56:59], v182, s[16:19], s77 offen sc0 sc1
K_END:
    s_endpgm
.section .rodata,"a"
.p2align 6
.amdhsa_kernel recurrent_scan__linear_attn_block__glu_gated_geglu__prompt_kernel
  .amdhsa_next_free_vgpr 256
  .amdhsa_next_free_sgpr 102
  .amdhsa_accum_offset 256
  .amdhsa_group_segment_fixed_size 0
  .amdhsa_kernarg_size 80
  .amdhsa_user_sgpr_count 2
  .amdhsa_user_sgpr_kernarg_segment_ptr 1
  .amdhsa_system_sgpr_workgroup_id_x 1
.end_amdhsa_kernel
```
